```python
import torch

def _softmax(x, axis=-1):
    return torch.softmax(x, dim=axis)
def _gelu(x):
    return torch.nn.functional.gelu(x, approximate="tanh")
def _silu(x):
    return torch.nn.functional.silu(x)
def _sigmoid(x):
    return torch.sigmoid(x)
def _layernorm(x, axis=-1, eps=1e-5):
    m = x.mean(dim=axis, keepdim=True)
    v = x.var(dim=axis, keepdim=True, unbiased=False)
    return (x - m) / torch.sqrt(v + eps)
def _scatter_add(tgt, idx, src, axis=0):
    return tgt.clone().index_add_(axis, idx, src)
def _segment_sum(src, seg, n):
    out = torch.zeros((n,) + src.shape[1:], dtype=src.dtype)
    return out.index_add_(0, seg, src)
def _pad(x, pw):
    flat = tuple(v for pair in reversed(pw) for v in pair)
    return torch.nn.functional.pad(x, flat)

kernel_name = 'concat_heads__gqa_block_cached__sliding_block_cached__decode'

def setup_inputs():

    _w = (lambda a: (lambda t: t.to(torch.bfloat16) if t.is_floating_point() else t)(torch.as_tensor(a)))
    def _A_setup():
        B, Sq, D = 2, 1, 1024
        Hq, Hkv, Sk, Dh = 32, 4, 32768, 128
        assert Hq % Hkv == 0, (Hq, Hkv)
        return {
            "x": _w((lambda *s: torch.randn(*s, dtype=torch.bfloat16) * 0.8)(B, Sq, D)),
            "k_cache": _w((lambda *s: torch.randn(*s, dtype=torch.bfloat16) * 1.6)(B, Hkv, Sk, Dh)),
            "v_cache": _w((lambda *s: torch.randn(*s, dtype=torch.bfloat16) * 0.2)(B, Hkv, Sk, Dh)),
            "wq": _w((lambda *s: torch.randn(*s, dtype=torch.bfloat16) * 1.6)(D, Hq * Dh) * (D ** -0.5)),
            "wo": _w((lambda *s: torch.randn(*s, dtype=torch.bfloat16) * 0.2)(Hq * Dh, D) * ((Hq * Dh) ** -0.5)),
        }
    _A_in = _A_setup()

    def _B_setup():
        B, Sq, D = 2, 1, 1024
        Hq, Hkv, Sk, Dh = 32, 4, 32768, 128
        assert Hq % Hkv == 0, (Hq, Hkv)
        return {
            "x": _w((lambda *s: torch.randn(*s, dtype=torch.bfloat16) * 0.8)(B, Sq, D)),
            "k_cache": _w((lambda *s: torch.randn(*s, dtype=torch.bfloat16) * 1.6)(B, Hkv, Sk, Dh)),
            "v_cache": _w((lambda *s: torch.randn(*s, dtype=torch.bfloat16) * 0.2)(B, Hkv, Sk, Dh)),
            "wq": _w((lambda *s: torch.randn(*s, dtype=torch.bfloat16) * 1.6)(D, Hq * Dh) * (D ** -0.5)),
            "wo": _w((lambda *s: torch.randn(*s, dtype=torch.bfloat16) * 0.2)(Hq * Dh, D) * ((Hq * Dh) ** -0.5)),
        }
    _B_in = _B_setup()

    return {
        "A_x": _A_in["x"],
        "A_k_cache": _A_in["k_cache"],
        "A_v_cache": _A_in["v_cache"],
        "A_wq": _A_in["wq"],
        "A_wo": _A_in["wo"],
        "B_x": _B_in["x"],
        "B_k_cache": _B_in["k_cache"],
        "B_v_cache": _B_in["v_cache"],
        "B_wq": _B_in["wq"],
        "B_wo": _B_in["wo"],
    }

def reference(A_x, A_k_cache, A_v_cache, A_wq, A_wo, B_x, B_k_cache, B_v_cache, B_wq, B_wo):
    def _A_ref(x, k_cache, v_cache, wq, wo):
        B, Sq, D = x.shape
        Hq, Dh = 32, 128
        Hkv = k_cache.shape[1]
        rep = Hq // Hkv
        q = (lambda x, *d: x.permute(*d))((x @ wq).reshape(B, Sq, Hq, Dh), 0, 2, 1, 3)
        k = (lambda x, n, axis: torch.repeat_interleave(x, n, dim=axis))(k_cache, rep, axis=1)
        v = (lambda x, n, axis: torch.repeat_interleave(x, n, dim=axis))(v_cache, rep, axis=1)
        scores = torch.einsum("bhqd,bhkd->bhqk", q, k) * (Dh ** -0.5)
        p = _softmax(scores, axis=-1)
        o = torch.einsum("bhqk,bhkd->bhqd", p, v)
        return (lambda x, *d: x.permute(*d))(o, 0, 2, 1, 3).reshape(B, Sq, Hq * Dh) @ wo

    def _B_ref(x, k_cache, v_cache, wq, wo):
        B, Sq, D = x.shape
        Hq, Dh = 32, 128
        Hkv, Sk = k_cache.shape[1], k_cache.shape[2]
        W = min(4096, max(256, Sk // 4))
        rep = Hq // Hkv
        q = (lambda x, *d: x.permute(*d))((x @ wq).reshape(B, Sq, Hq, Dh), 0, 2, 1, 3)
        k = (lambda x, n, axis: torch.repeat_interleave(x, n, dim=axis))(k_cache[:, :, Sk - W:, :], rep, axis=1)
        v = (lambda x, n, axis: torch.repeat_interleave(x, n, dim=axis))(v_cache[:, :, Sk - W:, :], rep, axis=1)
        scores = torch.einsum("bhqd,bhkd->bhqk", q, k) * (Dh ** -0.5)
        p = _softmax(scores, axis=-1)
        o = torch.einsum("bhqk,bhkd->bhqd", p, v)
        return (lambda x, *d: x.permute(*d))(o, 0, 2, 1, 3).reshape(B, Sq, Hq * Dh) @ wo

    a = _A_ref(A_x, A_k_cache, A_v_cache, A_wq, A_wo)
    b = _B_ref(B_x, B_k_cache, B_v_cache, B_wq, B_wo)
    return torch.concatenate([a, b], axis=-1)
```

```asm
; @launch grid=(256,1,1) block=(384,1,1) lds=155392
.amdgcn_target "amdgcn-amd-amdhsa--gfx950"
.text
.globl concat_heads__gqa_block_cached__sliding_block_cached__decode_kernel
.p2align 8
.type concat_heads__gqa_block_cached__sliding_block_cached__decode_kernel,@function
concat_heads__gqa_block_cached__sliding_block_cached__decode_kernel:
    s_cmp_ge_u32 s2, 256
    s_cbranch_scc1 L_end
    s_load_dwordx16 s[4:19], s[0:1], 0
    s_load_dwordx8 s[20:27], s[0:1], 64
    s_load_dwordx2 s[28:29], s[0:1], 96
    v_lshrrev_b32 v1, 6, v0
    v_lshlrev_b32 v3, 3, v0
    v_mov_b32 v4, 0
    v_mov_b32 v5, 0
    v_readfirstlane_b32 s30, v1
    v_add_u32 v3, 149504, v3
    v_and_b32 v0, 63, v0
    ds_write_b64 v3, v[4:5]
    s_mov_b32 s31, 134217728
    s_mov_b32 s94, 0
    v_lshrrev_b32 v1, 4, v0
    v_and_b32 v2, 15, v0
    s_cmp_lg_u32 s30, 0
    s_cbranch_scc1 L_notloader
    s_setprio 3
    v_lshrrev_b32 v20, 3, v0
    v_and_b32 v21, 7, v0
    v_and_b32 v22, 1, v1
    v_lshlrev_b32 v20, 13, v20
    v_lshlrev_b32 v22, 1, v22
    v_xor_b32 v21, v21, v22
    v_lshl_add_u32 v4, v21, 4, v20
    v_xor_b32 v5, 64, v4
    s_mov_b32 s3, s2
    s_and_b32 s57, s3, 1
    s_lshl_b32 s56, s57, 22
    s_lshl_b32 s57, s57, 10
    s_bfe_u32 s58, s3, 0x60001
    s_lshl_b32 s58, s58, 7
    s_add_u32 s56, s56, s58
    s_mov_b32 s34, 0x800000
    s_mov_b32 s35, 0x20000
    s_movk_i32 s38, 0x1000
    s_mov_b32 s39, 0x20000
    v_lshlrev_b32 v18, 4, v0
    s_mov_b32 m0, 139264
    s_mov_b32 s40, 0
    s_mov_b32 s41, 0
    s_cmp_lt_u32 s2, 128
    s_waitcnt lgkmcnt(0)
    s_cselect_b32 s32, s10, s20
    s_cselect_b32 s33, s11, s21
    s_cselect_b32 s36, s4, s14
    s_cselect_b32 s37, s5, s15
    s_and_b32 s33, s33, 0xffff
    s_and_b32 s37, s37, 0xffff
    buffer_load_dwordx4 v18, s[36:39], s57 offen lds
    s_add_u32 s57, s57, 1024
    buffer_load_dwordx4 v18, s[36:39], s57 offen offset:1024 lds
L_wq0:
    s_add_u32 m0, s41, 0
    s_nop 0
    buffer_load_dwordx4 v4, s[32:35], s56 offen offset:0 nt lds
    s_add_u32 s56, s56, 64512
    buffer_load_dwordx4 v5, s[32:35], s56 offen offset:1024 nt lds
    s_add_u32 s56, s56, 64512
    buffer_load_dwordx4 v4, s[32:35], s56 offen offset:2048 nt lds
    s_add_u32 s56, s56, 64512
    buffer_load_dwordx4 v5, s[32:35], s56 offen offset:3072 nt lds
    s_add_u32 s56, s56, 68608
    s_add_u32 m0, s41, 4096
    s_nop 0
    buffer_load_dwordx4 v4, s[32:35], s56 offen offset:0 nt lds
    s_add_u32 s56, s56, 64512
    buffer_load_dwordx4 v5, s[32:35], s56 offen offset:1024 nt lds
    s_add_u32 s56, s56, 64512
    buffer_load_dwordx4 v4, s[32:35], s56 offen offset:2048 nt lds
    s_add_u32 s56, s56, 64512
    buffer_load_dwordx4 v5, s[32:35], s56 offen offset:3072 nt lds
    s_add_u32 s56, s56, 68608
    s_add_u32 s40, s40, 1
    s_add_u32 s41, s41, 8192
    s_cmp_lt_u32 s40, 3
    s_cbranch_scc1 L_wq0
    s_barrier
    v_lshlrev_b32 v24, 2, v0
    v_add_u32 v24, 149504, v24
    v_add_u32 v20, 0, v1
    v_xor_b32 v20, v20, v2
    v_lshlrev_b32 v20, 4, v20
    v_lshl_add_u32 v12, v1, 8, v20
    v_add_u32 v20, 4, v1
    v_xor_b32 v20, v20, v2
    v_lshlrev_b32 v20, 4, v20
    v_lshl_add_u32 v13, v1, 8, v20
    v_add_u32 v20, 8, v1
    v_xor_b32 v20, v20, v2
    v_lshlrev_b32 v20, 4, v20
    v_lshl_add_u32 v14, v1, 8, v20
    v_add_u32 v20, 12, v1
    v_xor_b32 v20, v20, v2
    v_lshlrev_b32 v20, 4, v20
    v_lshl_add_u32 v15, v1, 8, v20
    v_add_u32 v20, 0, v1
    v_lshlrev_b32 v20, 1, v20
    v_xor_b32 v20, v20, v2
    v_lshlrev_b32 v20, 4, v20
    v_lshl_add_u32 v16, v1, 8, v20
    v_add_u32 v20, 4, v1
    v_lshlrev_b32 v20, 1, v20
    v_xor_b32 v20, v20, v2
    v_lshlrev_b32 v20, 4, v20
    v_lshl_add_u32 v17, v1, 8, v20
    v_mov_b32 v26, 149760
    v_mov_b32 v19, 155136
    s_lshr_b32 s93, s2, 5
    s_and_b32 s92, s2, 7
    s_cmp_eq_u32 s92, s93
    s_cselect_b32 s92, 1, 0
    s_and_b32 s59, s2, 31
    s_add_u32 s57, s59, 7
    s_sub_u32 s57, s57, s93
    s_lshr_b32 s57, s57, 3
    s_sub_u32 s57, s59, s57
    s_and_b32 s55, s93, 3
    s_lshl_b32 s55, s55, 3
    s_and_b32 s58, s93, 4
    s_add_u32 s55, s55, s58
    s_cmp_ge_i32 s57, s55
    s_cselect_b32 s58, 4, 0
    s_add_u32 s57, s57, s58
    s_lshl_b32 s57, s57, 18
    s_lshl_b32 s58, s93, 23
    s_add_u32 s57, s57, s58
    s_lshl_b32 s55, s55, 18
    s_add_u32 s55, s55, s58
    s_lshl_b32 s54, s59, 15
    s_add_u32 s55, s55, s54
    s_lshr_b32 s54, s59, 3
    s_lshl_b32 s54, s54, 18
    s_add_u32 s54, s54, s58
    s_add_u32 s54, s54, 7340032
    s_cmp_eq_u32 s92, 1
    s_cselect_b32 s48, s16, s6
    s_cselect_b32 s49, s17, s7
    s_cselect_b32 s50, s18, s8
    s_cselect_b32 s51, s19, s9
    s_cselect_b32 s54, s54, s57
    s_mov_b32 s89, s2
    s_bfe_u32 s59, s89, 0x60001
    s_lshl_b32 s59, s59, 17
    s_and_b32 s58, s89, 1
    s_lshl_b32 s58, s58, 10
    s_add_u32 s59, s59, s58
    s_cmp_lt_u32 s2, 128
    s_cselect_b32 s52, s12, s22
    s_cselect_b32 s53, s13, s23
    s_mov_b32 s61, 0
L_wq1:
    s_add_u32 m0, s41, 0
    s_nop 0
    buffer_load_dwordx4 v4, s[32:35], s56 offen offset:0 nt lds
    s_add_u32 s56, s56, 64512
    s_waitcnt vmcnt(23)
    buffer_load_dwordx4 v5, s[32:35], s56 offen offset:1024 nt lds
    s_add_u32 s56, s56, 64512
    s_waitcnt vmcnt(23)
    buffer_load_dwordx4 v4, s[32:35], s56 offen offset:2048 nt lds
    s_add_u32 s56, s56, 64512
    s_waitcnt vmcnt(23)
    buffer_load_dwordx4 v5, s[32:35], s56 offen offset:3072 nt lds
    s_add_u32 s56, s56, 68608
    s_waitcnt vmcnt(23)
    s_add_u32 m0, s41, 4096
    s_nop 0
    buffer_load_dwordx4 v4, s[32:35], s56 offen offset:0 nt lds
    s_add_u32 s56, s56, 64512
    s_waitcnt vmcnt(23)
    buffer_load_dwordx4 v5, s[32:35], s56 offen offset:1024 nt lds
    s_add_u32 s56, s56, 64512
    s_waitcnt vmcnt(23)
    buffer_load_dwordx4 v4, s[32:35], s56 offen offset:2048 nt lds
    s_add_u32 s56, s56, 64512
    s_waitcnt vmcnt(23)
    s_sub_i32 s42, s40, 2
    s_max_i32 s42, s42, 0
    v_mov_b32 v25, s42
    ds_write_b32 v24, v25
    buffer_load_dwordx4 v5, s[32:35], s56 offen offset:3072 nt lds
    s_add_u32 s56, s56, 68608
    s_waitcnt vmcnt(23)
    s_add_u32 s40, s40, 1
    s_add_u32 s41, s41, 8192
    s_cmp_lt_u32 s40, 8
    s_cbranch_scc1 L_wq1
    s_mov_b32 s32, s48
    s_and_b32 s33, s49, 0xffff
    s_mov_b32 s34, 0x4000000
    s_add_u32 s56, s54, 0
    v_mov_b32 v4, v12
    v_mov_b32 v5, v13
    v_mov_b32 v6, v14
    v_mov_b32 v7, v15
    v_mov_b32 v8, v12
    v_mov_b32 v9, v13
    v_mov_b32 v10, v14
    v_mov_b32 v11, v15
    s_mov_b32 s44, 4096
    s_mov_b32 s43, 40
    s_call_b64 s[46:47], L_tile
    s_mov_b32 s32, s6
    s_and_b32 s33, s7, 0xffff
    s_mov_b32 s34, 0x4000000
    s_add_u32 s56, s55, 0
    s_mov_b32 s43, 44
    s_call_b64 s[46:47], L_tile
    s_mov_b32 s32, s52
    s_and_b32 s33, s53, 0xffff
    s_mov_b32 s34, 0x800000
    s_add_u32 s56, s59, 0
    v_xor_b32 v4, 0, v18
    v_xor_b32 v5, 32, v18
    v_add_u32 v5, 1024, v5
    v_xor_b32 v6, 64, v18
    v_add_u32 v6, 2048, v6
    v_xor_b32 v7, 96, v18
    v_add_u32 v7, 3072, v7
    v_xor_b32 v8, 128, v18
    v_xor_b32 v9, 160, v18
    v_add_u32 v9, 1024, v9
    v_xor_b32 v10, 192, v18
    v_add_u32 v10, 2048, v10
    v_xor_b32 v11, 224, v18
    v_add_u32 v11, 3072, v11
    s_mov_b32 s44, 8192
    s_mov_b32 s43, 48
    s_call_b64 s[46:47], L_tile
    s_mov_b32 s32, s50
    s_and_b32 s33, s51, 0xffff
    s_mov_b32 s34, 0x4000000
    s_add_u32 s56, s54, 0
    v_mov_b32 v4, v16
    v_mov_b32 v5, v17
    v_mov_b32 v6, v16
    v_mov_b32 v7, v17
    v_mov_b32 v8, v16
    v_mov_b32 v9, v17
    v_mov_b32 v10, v16
    v_mov_b32 v11, v17
    s_mov_b32 s44, 4096
    s_mov_b32 s43, 56
    s_call_b64 s[46:47], L_tile
    ds_read_b32 v27, v19
    s_waitcnt lgkmcnt(0)
    v_readfirstlane_b32 s62, v27
    s_mov_b32 s43, 80
    s_call_b64 s[46:47], L_disp
    s_mov_b32 s32, s8
    s_and_b32 s33, s9, 0xffff
    s_mov_b32 s34, 0x4000000
    s_add_u32 s56, s55, 0
    s_mov_b32 s43, 84
    s_call_b64 s[46:47], L_tileT
    s_mov_b32 s32, s52
    s_and_b32 s33, s53, 0xffff
    s_mov_b32 s34, 0x800000
    s_add_u32 s56, s59, 65536
    v_xor_b32 v4, 0, v18
    v_xor_b32 v5, 32, v18
    v_add_u32 v5, 1024, v5
    v_xor_b32 v6, 64, v18
    v_add_u32 v6, 2048, v6
    v_xor_b32 v7, 96, v18
    v_add_u32 v7, 3072, v7
    v_xor_b32 v8, 128, v18
    v_xor_b32 v9, 160, v18
    v_add_u32 v9, 1024, v9
    v_xor_b32 v10, 192, v18
    v_add_u32 v10, 2048, v10
    v_xor_b32 v11, 224, v18
    v_add_u32 v11, 3072, v11
    s_mov_b32 s44, 8192
    s_mov_b32 s43, 88
    s_call_b64 s[46:47], L_tileT
    s_waitcnt vmcnt(24)
    v_mov_b32 v25, 85
    ds_write_b32 v24, v25
    s_waitcnt vmcnt(16)
    v_mov_b32 v25, 86
    ds_write_b32 v24, v25
    s_waitcnt vmcnt(8)
    v_mov_b32 v25, 87
    ds_write_b32 v24, v25
    s_waitcnt vmcnt(0)
    v_mov_b32 v25, 88
    ds_write_b32 v24, v25
    s_waitcnt lgkmcnt(0)
    s_cmp_eq_u32 s94, 0
    s_cbranch_scc1 L_dg_1
    s_mov_b64 exec, 1
    s_lshl_b32 s95, s2, 8
    s_or_b32 s95, s95, s94
    v_mov_b32 v1, s95
    v_mov_b32 v2, 0
    v_mov_b32 v3, 1
    global_store_dword v2, v1, s[26:27] offset:0 sc1
    global_atomic_add v2, v3, s[26:27] offset:16 sc1
    s_waitcnt vmcnt(0)
L_dg_1:
    s_endpgm
L_tile:
    s_sub_i32 s42, s40, 16
L_pm_2:
    s_cmp_gt_i32 s61, s42
    s_cbranch_scc1 L_ok_3
    ds_read_b128 v[28:31], v26
    s_waitcnt lgkmcnt(0)
    v_min3_u32 v28, v28, v29, v30
    v_min_u32 v28, v28, v31
    s_nop 0
    v_readfirstlane_b32 s61, v28
    s_sub_u32 s31, s31, 1
    s_cbranch_scc0 L_pm_2
    s_mov_b32 s31, 0
    s_cmp_eq_u32 s94, 0
    s_cselect_b32 s94, 1, s94
L_ok_3:
    s_mov_b32 m0, s41
    s_add_u32 s45, s56, s44
    buffer_load_dwordx4 v4, s[32:35], s56 offen offset:0 nt lds
    s_waitcnt vmcnt(20)
    buffer_load_dwordx4 v5, s[32:35], s56 offen offset:1024 nt lds
    s_waitcnt vmcnt(20)
    buffer_load_dwordx4 v6, s[32:35], s56 offen offset:2048 nt lds
    s_waitcnt vmcnt(20)
    buffer_load_dwordx4 v7, s[32:35], s56 offen offset:3072 nt lds
    s_waitcnt vmcnt(20)
    s_sub_i32 s42, s40, 2
    s_max_i32 s42, s42, 0
    v_mov_b32 v25, s42
    ds_write_b32 v24, v25
    s_add_u32 m0, s41, 4096
    s_add_u32 s41, s41, 8192
    buffer_load_dwordx4 v8, s[32:35], s45 offen offset:0 nt lds
    s_and_b32 s41, s41, 131071
    s_waitcnt vmcnt(20)
    buffer_load_dwordx4 v9, s[32:35], s45 offen offset:1024 nt lds
    s_add_u32 s56, s45, s44
    s_waitcnt vmcnt(20)
    buffer_load_dwordx4 v10, s[32:35], s45 offen offset:2048 nt lds
    s_waitcnt vmcnt(20)
    buffer_load_dwordx4 v11, s[32:35], s45 offen offset:3072 nt lds
    s_waitcnt vmcnt(20)
    s_add_u32 s40, s40, 1
    s_cmp_lt_u32 s40, s43
    s_cbranch_scc1 L_tile
    s_setpc_b64 s[46:47]
L_disp:
    s_cmp_eq_u32 s62, 1
    s_cbranch_scc1 L_tile
    s_cmp_eq_u32 s62, 2
    s_cbranch_scc1 L_disp_2
    s_cmp_eq_u32 s62, 3
    s_cbranch_scc1 L_disp_3
L_disp_0:
    s_sub_i32 s42, s40, 16
L_pm_4:
    s_cmp_gt_i32 s61, s42
    s_cbranch_scc1 L_ok_5
    ds_read_b128 v[28:31], v26
    s_waitcnt lgkmcnt(0)
    v_min3_u32 v28, v28, v29, v30
    v_min_u32 v28, v28, v31
    s_nop 0
    v_readfirstlane_b32 s61, v28
    s_sub_u32 s31, s31, 1
    s_cbranch_scc0 L_pm_4
    s_mov_b32 s31, 0
    s_cmp_eq_u32 s94, 0
    s_cselect_b32 s94, 2, s94
L_ok_5:
    s_mov_b32 m0, s41
    s_add_u32 s45, s56, s44
    buffer_load_dwordx4 v4, s[32:35], s56 offen offset:0 nt lds
    s_waitcnt vmcnt(19)
    buffer_load_dwordx4 v5, s[32:35], s56 offen offset:1024 nt lds
    s_waitcnt vmcnt(19)
    buffer_load_dwordx4 v6, s[32:35], s56 offen offset:2048 nt lds
    s_waitcnt vmcnt(19)
    s_sub_i32 s42, s40, 2
    s_max_i32 s42, s42, 0
    v_mov_b32 v25, s42
    ds_write_b32 v24, v25
    buffer_load_dwordx4 v7, s[32:35], s56 offen offset:3072 nt lds
    s_waitcnt vmcnt(19)
    s_add_u32 m0, s41, 4096
    s_add_u32 s41, s41, 8192
    buffer_load_dwordx4 v8, s[32:35], s45 offen offset:0 nt lds
    s_and_b32 s41, s41, 131071
    s_waitcnt vmcnt(19)
    buffer_load_dwordx4 v9, s[32:35], s45 offen offset:1024 nt lds
    s_add_u32 s56, s45, s44
    s_waitcnt vmcnt(19)
    buffer_load_dwordx4 v10, s[32:35], s45 offen offset:2048 nt lds
    s_waitcnt vmcnt(19)
    buffer_load_dwordx4 v11, s[32:35], s45 offen offset:3072 nt lds
    s_waitcnt vmcnt(19)
    s_add_u32 s40, s40, 1
    s_cmp_lt_u32 s40, s43
    s_cbranch_scc1 L_disp_0
    s_setpc_b64 s[46:47]
L_disp_2:
    s_sub_i32 s42, s40, 16
L_pm_6:
    s_cmp_gt_i32 s61, s42
    s_cbranch_scc1 L_ok_7
    ds_read_b128 v[28:31], v26
    s_waitcnt lgkmcnt(0)
    v_min3_u32 v28, v28, v29, v30
    v_min_u32 v28, v28, v31
    s_nop 0
    v_readfirstlane_b32 s61, v28
    s_sub_u32 s31, s31, 1
    s_cbranch_scc0 L_pm_6
    s_mov_b32 s31, 0
    s_cmp_eq_u32 s94, 0
    s_cselect_b32 s94, 3, s94
L_ok_7:
    s_mov_b32 m0, s41
    s_add_u32 s45, s56, s44
    buffer_load_dwordx4 v4, s[32:35], s56 offen offset:0 nt lds
    s_waitcnt vmcnt(23)
    buffer_load_dwordx4 v5, s[32:35], s56 offen offset:1024 nt lds
    s_waitcnt vmcnt(23)
    buffer_load_dwordx4 v6, s[32:35], s56 offen offset:2048 nt lds
    s_waitcnt vmcnt(23)
    buffer_load_dwordx4 v7, s[32:35], s56 offen offset:3072 nt lds
    s_waitcnt vmcnt(23)
    s_add_u32 m0, s41, 4096
    s_add_u32 s41, s41, 8192
    buffer_load_dwordx4 v8, s[32:35], s45 offen offset:0 nt lds
    s_and_b32 s41, s41, 131071
    s_waitcnt vmcnt(23)
    buffer_load_dwordx4 v9, s[32:35], s45 offen offset:1024 nt lds
    s_add_u32 s56, s45, s44
    s_waitcnt vmcnt(23)
    buffer_load_dwordx4 v10, s[32:35], s45 offen offset:2048 nt lds
    s_waitcnt vmcnt(23)
    s_sub_i32 s42, s40, 2
    s_max_i32 s42, s42, 0
    v_mov_b32 v25, s42
    ds_write_b32 v24, v25
    buffer_load_dwordx4 v11, s[32:35], s45 offen offset:3072 nt lds
    s_waitcnt vmcnt(23)
    s_add_u32 s40, s40, 1
    s_cmp_lt_u32 s40, s43
    s_cbranch_scc1 L_disp_2
    s_setpc_b64 s[46:47]
L_disp_3:
    s_sub_i32 s42, s40, 16
L_pm_8:
    s_cmp_gt_i32 s61, s42
    s_cbranch_scc1 L_ok_9
    ds_read_b128 v[28:31], v26
    s_waitcnt lgkmcnt(0)
    v_min3_u32 v28, v28, v29, v30
    v_min_u32 v28, v28, v31
    s_nop 0
    v_readfirstlane_b32 s61, v28
    s_sub_u32 s31, s31, 1
    s_cbranch_scc0 L_pm_8
    s_mov_b32 s31, 0
    s_cmp_eq_u32 s94, 0
    s_cselect_b32 s94, 4, s94
L_ok_9:
    s_mov_b32 m0, s41
    s_add_u32 s45, s56, s44
    buffer_load_dwordx4 v4, s[32:35], s56 offen offset:0 nt lds
    s_waitcnt vmcnt(26)
    buffer_load_dwordx4 v5, s[32:35], s56 offen offset:1024 nt lds
    s_waitcnt vmcnt(26)
    s_sub_i32 s42, s40, 3
    s_max_i32 s42, s42, 0
    v_mov_b32 v25, s42
    ds_write_b32 v24, v25
    buffer_load_dwordx4 v6, s[32:35], s56 offen offset:2048 nt lds
    s_waitcnt vmcnt(26)
    buffer_load_dwordx4 v7, s[32:35], s56 offen offset:3072 nt lds
    s_waitcnt vmcnt(26)
    s_add_u32 m0, s41, 4096
    s_add_u32 s41, s41, 8192
    buffer_load_dwordx4 v8, s[32:35], s45 offen offset:0 nt lds
    s_and_b32 s41, s41, 131071
    s_waitcnt vmcnt(26)
    buffer_load_dwordx4 v9, s[32:35], s45 offen offset:1024 nt lds
    s_add_u32 s56, s45, s44
    s_waitcnt vmcnt(26)
    buffer_load_dwordx4 v10, s[32:35], s45 offen offset:2048 nt lds
    s_waitcnt vmcnt(26)
    buffer_load_dwordx4 v11, s[32:35], s45 offen offset:3072 nt lds
    s_waitcnt vmcnt(26)
    s_add_u32 s40, s40, 1
    s_cmp_lt_u32 s40, s43
    s_cbranch_scc1 L_disp_3
    s_setpc_b64 s[46:47]
L_tileT:
    s_sub_i32 s42, s40, 16
L_pm_10:
    s_cmp_gt_i32 s61, s42
    s_cbranch_scc1 L_ok_11
    ds_read_b128 v[28:31], v26
    s_waitcnt lgkmcnt(0)
    v_min3_u32 v28, v28, v29, v30
    v_min_u32 v28, v28, v31
    s_nop 0
    v_readfirstlane_b32 s61, v28
    s_sub_u32 s31, s31, 1
    s_cbranch_scc0 L_pm_10
    s_mov_b32 s31, 0
    s_cmp_eq_u32 s94, 0
    s_cselect_b32 s94, 5, s94
L_ok_11:
    s_mov_b32 m0, s41
    s_add_u32 s45, s56, s44
    buffer_load_dwordx4 v4, s[32:35], s56 offen offset:0 nt lds
    s_waitcnt vmcnt(31)
    buffer_load_dwordx4 v5, s[32:35], s56 offen offset:1024 nt lds
    s_waitcnt vmcnt(31)
    buffer_load_dwordx4 v6, s[32:35], s56 offen offset:2048 nt lds
    s_waitcnt vmcnt(31)
    buffer_load_dwordx4 v7, s[32:35], s56 offen offset:3072 nt lds
    s_waitcnt vmcnt(31)
    s_add_u32 m0, s41, 4096
    s_add_u32 s41, s41, 8192
    buffer_load_dwordx4 v8, s[32:35], s45 offen offset:0 nt lds
    s_and_b32 s41, s41, 131071
    s_waitcnt vmcnt(31)
    buffer_load_dwordx4 v9, s[32:35], s45 offen offset:1024 nt lds
    s_add_u32 s56, s45, s44
    s_waitcnt vmcnt(31)
    buffer_load_dwordx4 v10, s[32:35], s45 offen offset:2048 nt lds
    s_waitcnt vmcnt(31)
    s_sub_i32 s42, s40, 3
    s_max_i32 s42, s42, 0
    v_mov_b32 v25, s42
    ds_write_b32 v24, v25
    buffer_load_dwordx4 v11, s[32:35], s45 offen offset:3072 nt lds
    s_waitcnt vmcnt(31)
    s_add_u32 s40, s40, 1
    s_cmp_lt_u32 s40, s43
    s_cbranch_scc1 L_tileT
    s_setpc_b64 s[46:47]
L_notloader:
    s_cmp_gt_u32 s30, 1
    s_cbranch_scc1 L_cons
    v_lshlrev_b32 v24, 2, v0
    v_add_u32 v24, 151808, v24
    v_mov_b32 v10, 0
    s_memrealtime s[90:91]
    s_waitcnt lgkmcnt(0)
    s_cmp_lg_u32 s2, 0
    s_cbranch_scc1 L_nononce
    s_or_b32 s90, s90, 1
    s_or_b32 s91, s91, 0x80000000
    v_mov_b32 v60, s90
    v_mov_b32 v61, s91
    s_mov_b64 exec, 1
    global_store_dwordx2 v10, v[60:61], s[26:27] offset:128 sc1
    s_mov_b64 exec, -1
L_nononce:
    s_barrier
    s_mov_b32 s41, 0
    v_mov_b32 v26, 150784
    s_mov_b32 s42, 0
    v_mov_b32 v27, 149504
    s_lshl_b32 s32, s2, 8
    s_add_u32 s32, s32, 0x20000
    s_add_u32 s38, s28, s32
    s_addc_u32 s39, s29, 0
    s_mov_b32 s89, s2
    s_bfe_u32 s32, s89, 0x20005
    s_lshl_b32 s32, s32, 13
    s_bfe_u32 s33, s89, 0x30002
    s_lshl_b32 s33, s33, 4
    s_add_u32 s32, s32, s33
    s_lshr_b32 s33, s2, 7
    s_lshl_b32 s33, s33, 7
    s_add_u32 s32, s32, s33
    s_add_u32 s32, s32, 0x20000
    s_add_u32 s34, s28, s32
    s_addc_u32 s35, s29, 0
    v_lshrrev_b32 v12, 5, v0
    v_lshlrev_b32 v12, 15, v12
    v_and_b32 v16, 31, v0
    v_lshl_add_u32 v12, v16, 8, v12
    v_and_b32 v13, 7, v0
    v_lshlrev_b32 v13, 2, v13
    v_add_u32 v13, 152576, v13
    v_lshlrev_b32 v11, 4, v2
    s_lshr_b32 s93, s2, 5
    s_and_b32 s92, s2, 7
    s_cmp_eq_u32 s92, s93
    s_cselect_b32 s92, 1, 0
    s_bfe_u32 s32, s89, 0x20005
    s_lshl_b32 s44, 0x01010101, s32
    s_lshl_b32 s45, s44, 4
    s_cmp_lt_u32 s2, 128
    s_cselect_b64 s[44:45], -1, s[44:45]
    s_cmp_eq_u32 s92, 1
    s_cselect_b32 s48, 0xff, 0
    s_mov_b32 s49, 0
    s_cselect_b32 s50, 0xff00, 0
    s_mov_b32 s51, 0
    s_or_b32 s46, s50, s48
    s_or_b32 s46, s46, 0xff
    s_mov_b32 s47, 0
L_pw_12:
    s_cmp_gt_u32 s42, 0
    s_cbranch_scc1 L_ok_13
    s_sleep 2
    ds_read_b32 v28, v27
    s_waitcnt lgkmcnt(0)
    v_readfirstlane_b32 s42, v28
    s_sub_u32 s31, s31, 2
    s_cbranch_scc0 L_pw_12
    s_mov_b32 s31, 0
    s_cmp_eq_u32 s94, 0
    s_cselect_b32 s94, 6, s94
L_ok_13:
    global_load_dwordx2 v[60:61], v10, s[26:27] offset:128 sc1
L_pv_14:
    s_mov_b64 exec, -1
    s_waitcnt vmcnt(0)
    v_min_u32 v18, v60, v61
    v_cmp_eq_u32 vcc, 0, v18
    s_cmp_eq_u64 vcc, 0
    s_cbranch_scc1 L_ok_15
    s_mov_b64 exec, vcc
    s_sleep 4
    global_load_dwordx2 v[60:61], v10, s[26:27] offset:128 sc1
    s_sub_u32 s31, s31, 64
    s_cbranch_scc0 L_pv_14
    s_mov_b32 s31, 0
    s_cmp_eq_u32 s94, 0
    s_cselect_b32 s94, 7, s94
    s_mov_b64 exec, -1
    s_waitcnt vmcnt(0)
L_ok_15:
    v_lshlrev_b32 v18, 3, v0
    v_add_u32 v18, 154624, v18
    ds_write_b64 v18, v[60:61]
    v_mov_b32 v25, 1
    ds_write_b32 v24, v25
    s_mov_b32 s60, 0x9e3779b1
    v_mul_lo_u32 v62, v60, s60
    s_mov_b32 s60, 0x85ebca6b
    v_xor_b32 v63, v61, v62
    v_mul_lo_u32 v63, v63, s60
    s_movk_i32 s60, 0x7ff
    v_and_b32 v56, s60, v62
    v_bfe_u32 v57, v62, 11, 10
    v_lshlrev_b32 v57, 1, v57
    v_and_b32 v58, 1, v62
    v_xor_b32 v58, 1, v58
    v_or_b32 v57, v57, v58
    v_lshrrev_b32 v58, 21, v62
    v_lshrrev_b32 v59, 21, v63
    v_mov_b32 v14, 0xff800000
    v_mov_b32 v15, 0
    v_mov_b32 v16, v62
    v_mov_b32 v17, v63
    s_add_u32 s64, s2, 9
    s_and_b32 s64, s64, 255
    s_lshl_b32 s64, s64, 8
    s_add_u32 s65, s2, 42
    s_and_b32 s65, s65, 255
    s_lshl_b32 s65, s65, 8
    s_add_u32 s66, s2, 75
    s_and_b32 s66, s66, 255
    s_lshl_b32 s66, s66, 8
    s_add_u32 s67, s2, 108
    s_and_b32 s67, s67, 255
    s_lshl_b32 s67, s67, 8
    s_add_u32 s68, s2, 141
    s_and_b32 s68, s68, 255
    s_lshl_b32 s68, s68, 8
    s_add_u32 s69, s2, 174
    s_and_b32 s69, s69, 255
    s_lshl_b32 s69, s69, 8
    s_add_u32 s70, s2, 207
    s_and_b32 s70, s70, 255
    s_lshl_b32 s70, s70, 8
    s_add_u32 s71, s2, 240
    s_and_b32 s71, s71, 255
    s_lshl_b32 s71, s71, 8
    s_add_u32 s72, s2, 33
    s_and_b32 s72, s72, 255
    s_lshl_b32 s72, s72, 8
    s_add_u32 s73, s2, 66
    s_and_b32 s73, s73, 255
    s_lshl_b32 s73, s73, 8
    s_add_u32 s74, s2, 99
    s_and_b32 s74, s74, 255
    s_lshl_b32 s74, s74, 8
    s_add_u32 s75, s2, 132
    s_and_b32 s75, s75, 255
    s_lshl_b32 s75, s75, 8
    s_add_u32 s76, s2, 165
    s_and_b32 s76, s76, 255
    s_lshl_b32 s76, s76, 8
    s_add_u32 s77, s2, 198
    s_and_b32 s77, s77, 255
    s_lshl_b32 s77, s77, 8
    s_add_u32 s78, s2, 231
    s_and_b32 s78, s78, 255
    s_lshl_b32 s78, s78, 8
    s_add_u32 s79, s2, 8
    s_and_b32 s79, s79, 255
    s_lshl_b32 s79, s79, 8
    s_add_u32 s52, s28, 0x20008
    s_addc_u32 s53, s29, 0
    v_readfirstlane_b32 s54, v62
    v_mov_b32 v25, 1
    ds_write_b32 v24, v25 offset:3328
L_pw_17:
    s_cmp_gt_u32 s42, 40
    s_cbranch_scc1 L_ok_18
    s_sleep 8
    ds_read_b32 v28, v27
    s_waitcnt lgkmcnt(0)
    v_readfirstlane_b32 s42, v28
    s_sub_u32 s31, s31, 5
    s_cbranch_scc0 L_pw_17
    s_mov_b32 s31, 0
    s_cmp_eq_u32 s94, 0
    s_cselect_b32 s94, 8, s94
L_ok_18:
    v_lshlrev_b32 v30, 7, v0
    s_lshl_b32 s32, s2, 11
    s_add_u32 s32, s32, 0x300000
    s_add_u32 s56, s28, s32
    s_addc_u32 s57, s29, 0
    s_mov_b32 exec_lo, 0xffff
    s_mov_b32 exec_hi, 0
    global_load_dword v31, v30, s[56:57]
    s_mov_b64 exec, -1
L_pm_19:
    s_cmp_gt_u32 s41, 2
    s_cbranch_scc1 L_ok_20
    s_sleep 8
    ds_read_b128 v[28:31], v26
    s_waitcnt lgkmcnt(0)
    v_min3_u32 v28, v28, v29, v30
    v_min_u32 v28, v28, v31
    s_nop 0
    v_readfirstlane_b32 s41, v28
    s_sub_u32 s31, s31, 5
    s_cbranch_scc0 L_pm_19
    s_mov_b32 s31, 0
    s_cmp_eq_u32 s94, 0
    s_cselect_b32 s94, 9, s94
L_ok_20:
    ds_read_b32 v32, v13 offset:0
    ds_read_b32 v36, v13 offset:32
    ds_read_b32 v40, v13 offset:256
    ds_read_b32 v44, v13 offset:288
    ds_read_b32 v33, v13 offset:64
    ds_read_b32 v37, v13 offset:96
    ds_read_b32 v41, v13 offset:320
    ds_read_b32 v45, v13 offset:352
    ds_read_b32 v34, v13 offset:128
    ds_read_b32 v38, v13 offset:160
    ds_read_b32 v42, v13 offset:384
    ds_read_b32 v46, v13 offset:416
    ds_read_b32 v35, v13 offset:192
    ds_read_b32 v39, v13 offset:224
    ds_read_b32 v43, v13 offset:448
    ds_read_b32 v47, v13 offset:480
    s_waitcnt lgkmcnt(0)
    v_max3_f32 v32, v32, v33, v34
    v_max_f32 v32, v32, v35
    v_max3_f32 v36, v36, v37, v38
    v_max_f32 v36, v36, v39
    v_add_f32 v40, v40, v41
    v_add_f32 v42, v42, v43
    v_add_f32 v40, v40, v42
    v_add_f32 v44, v44, v45
    v_add_f32 v46, v46, v47
    v_add_f32 v44, v44, v46
    v_max_f32 v60, v32, v36
    v_add_f32 v61, v40, v44
    v_cndmask_b32 v60, v60, v36, s[48:49]
    v_cndmask_b32 v61, v61, v44, s[48:49]
    v_cndmask_b32 v60, v60, v32, s[50:51]
    v_cndmask_b32 v61, v61, v40, s[50:51]
    s_mov_b64 exec, s[46:47]
    global_store_dwordx4 v11, v[60:63], s[38:39] sc1
    s_mov_b64 exec, -1
    s_load_dword s4, s[52:53], s64
    s_load_dword s5, s[52:53], s65
    s_load_dword s6, s[52:53], s66
    s_load_dword s7, s[52:53], s67
    s_load_dword s8, s[52:53], s68
    s_load_dword s9, s[52:53], s69
    s_load_dword s10, s[52:53], s70
    s_load_dword s11, s[52:53], s71
    s_load_dword s12, s[52:53], s72
    s_load_dword s13, s[52:53], s73
    s_load_dword s14, s[52:53], s74
    s_load_dword s15, s[52:53], s75
    s_load_dword s16, s[52:53], s76
    s_load_dword s17, s[52:53], s77
    s_load_dword s18, s[52:53], s78
    s_load_dword s19, s[52:53], s79
    s_mov_b32 s55, 0
    s_waitcnt lgkmcnt(0)
    s_cmp_eq_u32 s4, s54
    s_addc_u32 s55, s55, 0
    s_cmp_eq_u32 s5, s54
    s_addc_u32 s55, s55, 0
    s_cmp_eq_u32 s6, s54
    s_addc_u32 s55, s55, 0
    s_cmp_eq_u32 s7, s54
    s_addc_u32 s55, s55, 0
    s_cmp_eq_u32 s8, s54
    s_addc_u32 s55, s55, 0
    s_cmp_eq_u32 s9, s54
    s_addc_u32 s55, s55, 0
    s_cmp_eq_u32 s10, s54
    s_addc_u32 s55, s55, 0
    s_cmp_eq_u32 s11, s54
    s_addc_u32 s55, s55, 0
    s_cmp_eq_u32 s12, s54
    s_addc_u32 s55, s55, 0
    s_cmp_eq_u32 s13, s54
    s_addc_u32 s55, s55, 0
    s_cmp_eq_u32 s14, s54
    s_addc_u32 s55, s55, 0
    s_cmp_eq_u32 s15, s54
    s_addc_u32 s55, s55, 0
    s_cmp_eq_u32 s16, s54
    s_addc_u32 s55, s55, 0
    s_cmp_eq_u32 s17, s54
    s_addc_u32 s55, s55, 0
    s_cmp_eq_u32 s18, s54
    s_addc_u32 s55, s55, 0
    s_cmp_eq_u32 s19, s54
    s_addc_u32 s55, s55, 0
    s_mov_b32 s56, 0
    s_cmp_ge_u32 s55, 5
    s_addc_u32 s56, s56, 0
    s_cmp_ge_u32 s55, 11
    s_addc_u32 s56, s56, 0
    s_cmp_ge_u32 s55, 14
    s_addc_u32 s56, s56, 0
    v_mov_b32 v25, s56
    ds_write_b32 v24, v25 offset:3328
L_pw_21:
    s_cmp_gt_u32 s42, 64
    s_cbranch_scc1 L_ok_22
    s_sleep 8
    ds_read_b32 v28, v27
    s_waitcnt lgkmcnt(0)
    v_readfirstlane_b32 s42, v28
    s_sub_u32 s31, s31, 5
    s_cbranch_scc0 L_pw_21
    s_mov_b32 s31, 0
    s_cmp_eq_u32 s94, 0
    s_cselect_b32 s94, 10, s94
L_ok_22:
    s_mov_b64 exec, s[44:45]
    global_load_dwordx4 v[14:17], v12, s[34:35] sc1
L_pv_23:
    s_mov_b64 exec, -1
    s_waitcnt vmcnt(0)
    v_xor_b32 v18, v16, v62
    v_bitop3_b32 v18, v17, v63, v18 bitop3:0xbe
    v_cmp_ne_u32 vcc, 0, v18
    s_cmp_eq_u64 vcc, 0
    s_cbranch_scc1 L_ok_24
    s_mov_b64 exec, vcc
    s_sleep 8
    global_load_dwordx4 v[14:17], v12, s[34:35] sc1
    s_sub_u32 s31, s31, 64
    s_cbranch_scc0 L_pv_23
    s_mov_b32 s31, 0
    s_cmp_eq_u32 s94, 0
    s_cselect_b32 s94, 11, s94
    s_mov_b64 exec, -1
    s_waitcnt vmcnt(0)
L_ok_24:
    v_lshlrev_b32 v13, 2, v0
    v_add_u32 v13, 153088, v13
    v_mov_b32 v17, v14
    s_nop 1
    v_max_f32_dpp v17, v17, v17 row_ror:1 row_mask:0xf bank_mask:0xf
    s_nop 1
    v_max_f32_dpp v17, v17, v17 row_ror:2 row_mask:0xf bank_mask:0xf
    s_nop 1
    v_max_f32_dpp v17, v17, v17 row_ror:4 row_mask:0xf bank_mask:0xf
    s_nop 1
    v_max_f32_dpp v17, v17, v17 row_ror:8 row_mask:0xf bank_mask:0xf
    v_mov_b32 v18, v17
    s_nop 1
    v_permlane16_swap_b32 v17, v18
    v_max_f32 v17, v17, v18
    v_sub_f32 v14, v14, v17
    v_exp_f32 v14, v14
    s_nop 0
    v_mul_f32 v15, v15, v14
    s_nop 1
    v_add_f32_dpp v15, v15, v15 row_ror:1 row_mask:0xf bank_mask:0xf
    s_nop 1
    v_add_f32_dpp v15, v15, v15 row_ror:2 row_mask:0xf bank_mask:0xf
    s_nop 1
    v_add_f32_dpp v15, v15, v15 row_ror:4 row_mask:0xf bank_mask:0xf
    s_nop 1
    v_add_f32_dpp v15, v15, v15 row_ror:8 row_mask:0xf bank_mask:0xf
    v_mov_b32 v18, v15
    s_nop 1
    v_permlane16_swap_b32 v15, v18
    v_add_f32 v15, v15, v18
    v_rcp_f32 v15, v15
    s_nop 0
    v_mul_f32 v14, v14, v15
    ds_write_b32 v13, v14
    v_mov_b32 v25, 2
    ds_write_b32 v24, v25
    s_waitcnt lgkmcnt(0)
    s_cmp_eq_u32 s94, 0
    s_cbranch_scc1 L_dg_26
    s_mov_b64 exec, 1
    s_lshl_b32 s95, s2, 8
    s_or_b32 s95, s95, s94
    v_mov_b32 v1, s95
    v_mov_b32 v2, 0
    v_mov_b32 v3, 1
    global_store_dword v2, v1, s[26:27] offset:4 sc1
    global_atomic_add v2, v3, s[26:27] offset:20 sc1
    s_waitcnt vmcnt(0)
L_dg_26:
    s_endpgm
L_cons:
    s_waitcnt lgkmcnt(0)
    s_barrier
    s_sub_u32 s32, s30, 2
    s_mov_b32 s33, 0
    s_mov_b32 s34, 0
    s_mov_b32 s35, 0
    s_lshl_b32 s38, s32, 2
    v_lshl_add_u32 v4, v0, 4, s38
    v_add_u32 v5, 150784, v4
    v_add_u32 v4, 149760, v4
    v_mov_b32 v6, 149504
    v_mov_b32 v7, 151808
    v_mov_b32 v12, 150784
    v_bfe_u32 v13, v0, 2, 2
    v_and_b32 v14, 3, v0
    v_and_b32 v15, 1, v0
    v_lshlrev_b32 v15, 10, v15
    v_lshl_add_u32 v15, v1, 4, v15
    v_add_u32 v15, 139264, v15
    v_lshl_add_u32 v16, v1, 3, v13
    v_lshlrev_b32 v16, 7, v16
    v_lshrrev_b32 v17, 1, v13
    v_and_b32 v18, 1, v1
    v_lshl_or_b32 v17, v18, 1, v17
    v_lshlrev_b32 v17, 1, v17
    v_lshrrev_b32 v18, 1, v14
    s_lshl_b32 s38, s32, 1
    v_add_u32 v18, s38, v18
    v_xor_b32 v17, v17, v18
    v_lshl_add_u32 v16, v17, 4, v16
    v_and_b32 v18, 1, v14
    v_lshl_add_u32 v16, v18, 3, v16
    s_lshr_b32 s38, s2, 7
    s_lshl_b32 s38, s38, 16
    s_mov_b32 s3, s2
    s_and_b32 s39, s3, 1
    s_lshl_b32 s39, s39, 14
    s_add_u32 s38, s38, s39
    s_bfe_u32 s39, s3, 0x60001
    s_lshl_b32 s39, s39, 8
    s_add_u32 s38, s38, s39
    s_lshl_b32 s39, s32, 6
    s_add_u32 s38, s38, s39
    s_add_u32 s40, s28, s38
    s_addc_u32 s41, s29, 0
    v_and_b32 v34, 1, v0
    v_lshlrev_b32 v34, 15, v34
    v_lshl_add_u32 v34, v1, 4, v34
L_pw_27:
    s_cmp_gt_u32 s33, 0
    s_cbranch_scc1 L_ok_28
    ds_read_b32 v8, v6
    s_waitcnt lgkmcnt(0)
    v_readfirstlane_b32 s33, v8
    s_sub_u32 s31, s31, 1
    s_cbranch_scc0 L_pw_27
    s_mov_b32 s31, 0
    s_cmp_eq_u32 s94, 0
    s_cselect_b32 s94, 12, s94
L_ok_28:
    ds_read_b128 v[64:67], v15 offset:0
    ds_read_b128 v[68:71], v15 offset:64
    ds_read_b128 v[72:75], v15 offset:128
    ds_read_b128 v[76:79], v15 offset:192
    ds_read_b128 v[80:83], v15 offset:256
    ds_read_b128 v[84:87], v15 offset:320
    ds_read_b128 v[88:91], v15 offset:384
    ds_read_b128 v[92:95], v15 offset:448
    ds_read_b128 v[96:99], v15 offset:512
    ds_read_b128 v[100:103], v15 offset:576
    ds_read_b128 v[104:107], v15 offset:640
    ds_read_b128 v[108:111], v15 offset:704
    ds_read_b128 v[112:115], v15 offset:768
    ds_read_b128 v[116:119], v15 offset:832
    ds_read_b128 v[120:123], v15 offset:896
    ds_read_b128 v[124:127], v15 offset:960
    ds_read_b64_tr_b16 v[128:129], v16 offset:0
    ds_read_b64_tr_b16 v[130:131], v16 offset:512
    ds_read_b64_tr_b16 v[132:133], v16 offset:4096
    ds_read_b64_tr_b16 v[134:135], v16 offset:4608
    s_waitcnt lgkmcnt(0)
    v_mfma_f32_16x16x32_bf16 v[200:203], v[128:131], v[64:67], 0
    v_mfma_f32_16x16x32_bf16 v[200:203], v[132:135], v[68:71], v[200:203]
    v_mov_b32 v8, 1
    ds_write_b32 v4, v8
    v_lshrrev_b32 v17, 1, v1
    v_lshl_add_u32 v17, v17, 4, v2
    v_lshlrev_b32 v17, 8, v17
    s_lshl_b32 s38, s32, 13
    v_add_u32 v17, s38, v17
    v_and_b32 v18, 1, v1
    v_xor_b32 v18, v18, v2
    v_lshl_add_u32 v20, v18, 4, v17
    v_xor_b32 v21, 32, v20
    v_xor_b32 v22, 64, v20
    v_xor_b32 v23, 96, v20
    v_xor_b32 v24, 128, v20
    v_xor_b32 v25, 160, v20
    v_xor_b32 v26, 192, v20
    v_xor_b32 v27, 224, v20
L_pw_29:
    s_cmp_gt_u32 s33, 1
    s_cbranch_scc1 L_ok_30
    ds_read_b32 v8, v6
    s_waitcnt lgkmcnt(0)
    v_readfirstlane_b32 s33, v8
    s_sub_u32 s31, s31, 1
    s_cbranch_scc0 L_pw_29
    s_mov_b32 s31, 0
    s_cmp_eq_u32 s94, 0
    s_cselect_b32 s94, 13, s94
L_ok_30:
    ds_read_b64_tr_b16 v[128:129], v16 offset:8192
    ds_read_b64_tr_b16 v[130:131], v16 offset:8704
    ds_read_b64_tr_b16 v[132:133], v16 offset:12288
    ds_read_b64_tr_b16 v[134:135], v16 offset:12800
    s_waitcnt lgkmcnt(0)
    v_mfma_f32_16x16x32_bf16 v[200:203], v[128:131], v[72:75], v[200:203]
    v_mfma_f32_16x16x32_bf16 v[200:203], v[132:135], v[76:79], v[200:203]
    v_mov_b32 v8, 2
    ds_write_b32 v4, v8
    v_lshl_add_u32 v17, v1, 2, v13
    v_and_b32 v18, 7, v17
    v_lshlrev_b32 v18, 1, v18
    v_lshrrev_b32 v19, 1, v14
    v_xor_b32 v30, v18, v19
    v_and_b32 v31, 1, v14
    v_lshlrev_b32 v31, 3, v31
    v_lshl_add_u32 v30, v30, 4, v31
    s_lshl_b32 s38, s32, 6
    v_xor_b32 v28, s38, v30
    v_lshl_add_u32 v28, v17, 8, v28
    v_xor_b32 v29, 32, v28
    s_lshl_b32 s38, s32, 8
    v_add_u32 v40, s38, v30
    v_lshl_add_u32 v40, v17, 10, v40
    v_xor_b32 v41, 32, v40
    v_xor_b32 v42, 64, v40
    v_xor_b32 v43, 96, v40
    v_xor_b32 v44, 128, v40
    v_xor_b32 v45, 160, v40
    v_xor_b32 v46, 192, v40
    v_xor_b32 v47, 224, v40
    v_and_b32 v17, 7, v0
    v_lshl_add_u32 v17, v1, 3, v17
    v_lshlrev_b32 v17, 4, v17
    v_add_u32 v33, 131072, v17
    v_bfe_u32 v18, v0, 3, 1
    v_lshl_add_u32 v32, v18, 3, v33
    s_lshl_b32 s38, s32, 9
    v_add_u32 v32, s38, v32
L_pw_31:
    s_cmp_gt_u32 s33, 2
    s_cbranch_scc1 L_ok_32
    ds_read_b32 v8, v6
    s_waitcnt lgkmcnt(0)
    v_readfirstlane_b32 s33, v8
    s_sub_u32 s31, s31, 1
    s_cbranch_scc0 L_pw_31
    s_mov_b32 s31, 0
    s_cmp_eq_u32 s94, 0
    s_cselect_b32 s94, 14, s94
L_ok_32:
    ds_read_b64_tr_b16 v[128:129], v16 offset:16384
    ds_read_b64_tr_b16 v[130:131], v16 offset:16896
    ds_read_b64_tr_b16 v[132:133], v16 offset:20480
    ds_read_b64_tr_b16 v[134:135], v16 offset:20992
    s_waitcnt lgkmcnt(0)
    v_mfma_f32_16x16x32_bf16 v[200:203], v[128:131], v[80:83], v[200:203]
    v_mfma_f32_16x16x32_bf16 v[200:203], v[132:135], v[84:87], v[200:203]
    v_mov_b32 v8, 3
    ds_write_b32 v4, v8
    s_lshr_b32 s93, s2, 5
    s_and_b32 s92, s2, 7
    s_cmp_eq_u32 s92, s93
    s_cselect_b32 s92, 1, 0
    s_lshr_b32 s39, s2, 7
    s_lshl_b32 s38, s39, 15
    s_bfe_u32 s39, s2, 0x20005
    s_lshl_b32 s39, s39, 12
    s_add_u32 s38, s38, s39
    s_lshl_b32 s39, s32, 10
    s_add_u32 s38, s38, s39
    s_add_u32 s44, s28, s38
    s_addc_u32 s45, s29, 0
    s_lshl_b32 s39, s92, 16
    s_add_u32 s38, s38, s39
    s_add_u32 s42, s28, s38
    s_addc_u32 s43, s29, 0
    v_lshlrev_b32 v48, 4, v0
    v_add_u32 v36, 16384, v48
    s_lshl_b32 s38, s32, 9
    s_add_u32 s38, s38, 131072
    v_lshl_add_u32 v37, v0, 3, s38
    v_and_b32 v17, 7, v0
    v_lshlrev_b32 v17, 8, v17
    v_and_b32 v18, 1, v1
    v_lshl_add_u32 v17, v18, 4, v17
    v_add_u32 v35, 131072, v17
    s_lshl_b32 s39, s92, 11
    v_add_u32 v38, s39, v35
L_pw_33:
    s_cmp_gt_u32 s33, 3
    s_cbranch_scc1 L_ok_34
    ds_read_b32 v8, v6
    s_waitcnt lgkmcnt(0)
    v_readfirstlane_b32 s33, v8
    s_sub_u32 s31, s31, 1
    s_cbranch_scc0 L_pw_33
    s_mov_b32 s31, 0
    s_cmp_eq_u32 s94, 0
    s_cselect_b32 s94, 15, s94
L_ok_34:
    ds_read_b64_tr_b16 v[128:129], v16 offset:24576
    ds_read_b64_tr_b16 v[130:131], v16 offset:25088
    ds_read_b64_tr_b16 v[132:133], v16 offset:28672
    ds_read_b64_tr_b16 v[134:135], v16 offset:29184
    s_waitcnt lgkmcnt(0)
    v_mfma_f32_16x16x32_bf16 v[200:203], v[128:131], v[88:91], v[200:203]
    v_mfma_f32_16x16x32_bf16 v[200:203], v[132:135], v[92:95], v[200:203]
    v_mov_b32 v8, 4
    ds_write_b32 v4, v8
L_pw_35:
    s_cmp_gt_u32 s33, 4
    s_cbranch_scc1 L_ok_36
    ds_read_b32 v8, v6
    s_waitcnt lgkmcnt(0)
    v_readfirstlane_b32 s33, v8
    s_sub_u32 s31, s31, 1
    s_cbranch_scc0 L_pw_35
    s_mov_b32 s31, 0
    s_cmp_eq_u32 s94, 0
    s_cselect_b32 s94, 16, s94
L_ok_36:
    ds_read_b64_tr_b16 v[128:129], v16 offset:32768
    ds_read_b64_tr_b16 v[130:131], v16 offset:33280
    ds_read_b64_tr_b16 v[132:133], v16 offset:36864
    ds_read_b64_tr_b16 v[134:135], v16 offset:37376
    s_waitcnt lgkmcnt(0)
    v_mfma_f32_16x16x32_bf16 v[200:203], v[128:131], v[96:99], v[200:203]
    v_mfma_f32_16x16x32_bf16 v[200:203], v[132:135], v[100:103], v[200:203]
    v_mov_b32 v8, 5
    ds_write_b32 v4, v8
L_pw_37:
    s_cmp_gt_u32 s34, 0
    s_cbranch_scc1 L_ok_38
    ds_read_b32 v8, v7
    s_waitcnt lgkmcnt(0)
    v_readfirstlane_b32 s34, v8
    s_sub_u32 s31, s31, 1
    s_cbranch_scc0 L_pw_37
    s_mov_b32 s31, 0
    s_cmp_eq_u32 s94, 0
    s_cselect_b32 s94, 17, s94
L_ok_38:
    ds_read_b64 v[60:61], v7 offset:2816
    s_waitcnt lgkmcnt(0)
    s_mov_b32 s60, 0x9e3779b1
    v_mul_lo_u32 v62, v60, s60
    s_mov_b32 s60, 0x85ebca6b
    v_xor_b32 v63, v61, v62
    v_mul_lo_u32 v63, v63, s60
    s_movk_i32 s60, 0x7ff
    v_and_b32 v56, s60, v62
    v_bfe_u32 v57, v62, 11, 10
    v_lshlrev_b32 v57, 1, v57
    v_and_b32 v58, 1, v62
    v_xor_b32 v58, 1, v58
    v_or_b32 v57, v57, v58
    v_lshrrev_b32 v58, 21, v62
    v_lshrrev_b32 v59, 21, v63
L_pw_39:
    s_cmp_gt_u32 s33, 5
    s_cbranch_scc1 L_ok_40
    ds_read_b32 v8, v6
    s_waitcnt lgkmcnt(0)
    v_readfirstlane_b32 s33, v8
    s_sub_u32 s31, s31, 1
    s_cbranch_scc0 L_pw_39
    s_mov_b32 s31, 0
    s_cmp_eq_u32 s94, 0
    s_cselect_b32 s94, 18, s94
L_ok_40:
    ds_read_b64_tr_b16 v[128:129], v16 offset:40960
    ds_read_b64_tr_b16 v[130:131], v16 offset:41472
    ds_read_b64_tr_b16 v[132:133], v16 offset:45056
    ds_read_b64_tr_b16 v[134:135], v16 offset:45568
    s_waitcnt lgkmcnt(0)
    v_mfma_f32_16x16x32_bf16 v[200:203], v[128:131], v[104:107], v[200:203]
    v_mfma_f32_16x16x32_bf16 v[200:203], v[132:135], v[108:111], v[200:203]
    v_mov_b32 v8, 6
    ds_write_b32 v4, v8
L_pw_41:
    s_cmp_gt_u32 s33, 6
    s_cbranch_scc1 L_ok_42
    ds_read_b32 v8, v6
    s_waitcnt lgkmcnt(0)
    v_readfirstlane_b32 s33, v8
    s_sub_u32 s31, s31, 1
    s_cbranch_scc0 L_pw_41
    s_mov_b32 s31, 0
    s_cmp_eq_u32 s94, 0
    s_cselect_b32 s94, 19, s94
L_ok_42:
    ds_read_b64_tr_b16 v[128:129], v16 offset:49152
    ds_read_b64_tr_b16 v[130:131], v16 offset:49664
    ds_read_b64_tr_b16 v[132:133], v16 offset:53248
    ds_read_b64_tr_b16 v[134:135], v16 offset:53760
    s_waitcnt lgkmcnt(0)
    v_mfma_f32_16x16x32_bf16 v[200:203], v[128:131], v[112:115], v[200:203]
    v_mfma_f32_16x16x32_bf16 v[200:203], v[132:135], v[116:119], v[200:203]
    v_mov_b32 v8, 7
    ds_write_b32 v4, v8
L_pw_43:
    s_cmp_gt_u32 s33, 7
    s_cbranch_scc1 L_ok_44
    ds_read_b32 v8, v6
    s_waitcnt lgkmcnt(0)
    v_readfirstlane_b32 s33, v8
    s_sub_u32 s31, s31, 1
    s_cbranch_scc0 L_pw_43
    s_mov_b32 s31, 0
    s_cmp_eq_u32 s94, 0
    s_cselect_b32 s94, 20, s94
L_ok_44:
    ds_read_b64_tr_b16 v[128:129], v16 offset:57344
    ds_read_b64_tr_b16 v[130:131], v16 offset:57856
    ds_read_b64_tr_b16 v[132:133], v16 offset:61440
    ds_read_b64_tr_b16 v[134:135], v16 offset:61952
    s_waitcnt lgkmcnt(0)
    v_mfma_f32_16x16x32_bf16 v[200:203], v[128:131], v[120:123], v[200:203]
    v_mfma_f32_16x16x32_bf16 v[200:203], v[132:135], v[124:127], v[200:203]
    s_add_u32 s36, s32, 8
    v_mov_b32 v8, s36
    ds_write_b32 v4, v8
    s_mov_b32 exec_lo, 0x00030003
    s_mov_b32 exec_hi, 0x00030003
    s_nop 3
    v_bfi_b32 v200, s60, v56, v200
    v_bfi_b32 v201, s60, v57, v201
    v_bfi_b32 v202, s60, v58, v202
    v_bfi_b32 v203, s60, v59, v203
    global_store_dwordx4 v34, v[200:203], s[40:41] sc1
    s_mov_b64 exec, -1
    v_mov_b32 v64, 0
    v_mov_b32 v65, 0
    v_mov_b32 v66, 0
    v_mov_b32 v67, 0
    v_mov_b32 v68, 0
    v_mov_b32 v69, 0
    v_mov_b32 v70, 0
    v_mov_b32 v71, 0
    v_mov_b32 v72, 0
    v_mov_b32 v73, 0
    v_mov_b32 v74, 0
    v_mov_b32 v75, 0
    v_mov_b32 v76, 0
    v_mov_b32 v77, 0
    v_mov_b32 v78, 0
    v_mov_b32 v79, 0
    v_mov_b32 v80, 0
    v_mov_b32 v81, 0
    v_mov_b32 v82, 0
    v_mov_b32 v83, 0
    v_mov_b32 v84, 0
    v_mov_b32 v85, 0
    v_mov_b32 v86, 0
    v_mov_b32 v87, 0
    v_mov_b32 v88, 0
    v_mov_b32 v89, 0
    v_mov_b32 v90, 0
    v_mov_b32 v91, 0
    v_mov_b32 v92, 0
    v_mov_b32 v93, 0
    v_mov_b32 v94, 0
    v_mov_b32 v95, 0
    v_mov_b32 v96, 0
    v_mov_b32 v97, 0
    v_mov_b32 v98, 0
    v_mov_b32 v99, 0
    v_mov_b32 v100, 0
    v_mov_b32 v101, 0
    v_mov_b32 v102, 0
    v_mov_b32 v103, 0
    v_mov_b32 v104, 0
    v_mov_b32 v105, 0
    v_mov_b32 v106, 0
    v_mov_b32 v107, 0
    v_mov_b32 v108, 0
    v_mov_b32 v109, 0
    v_mov_b32 v110, 0
    v_mov_b32 v111, 0
    v_mov_b32 v112, 0
    v_mov_b32 v113, 0
    v_mov_b32 v114, 0
    v_mov_b32 v115, 0
    v_mov_b32 v116, 0
    v_mov_b32 v117, 0
    v_mov_b32 v118, 0
    v_mov_b32 v119, 0
    v_mov_b32 v120, 0
    v_mov_b32 v121, 0
    v_mov_b32 v122, 0
    v_mov_b32 v123, 0
    v_mov_b32 v124, 0
    v_mov_b32 v125, 0
    v_mov_b32 v126, 0
    v_mov_b32 v127, 0
    v_mov_b32 v136, v56
    v_mov_b32 v137, v57
    v_mov_b32 v138, v58
    v_mov_b32 v139, v59
    v_mov_b32 v140, v56
    v_mov_b32 v141, v57
    v_mov_b32 v142, v58
    v_mov_b32 v143, v59
L_pw_45:
    s_cmp_gt_u32 s33, 12
    s_cbranch_scc1 L_ok_46
    ds_read_b32 v8, v6
    s_waitcnt lgkmcnt(0)
    v_readfirstlane_b32 s33, v8
    s_sub_u32 s31, s31, 1
    s_cbranch_scc0 L_pw_45
    s_mov_b32 s31, 0
    s_cmp_eq_u32 s94, 0
    s_cselect_b32 s94, 21, s94
L_ok_46:
    global_load_dwordx4 v[128:131], v48, s[42:43] sc1
    global_load_dwordx4 v[132:135], v36, s[42:43] sc1
    s_cmp_eq_u32 s92, 0
    s_cbranch_scc1 L_qs_47
    global_load_dwordx4 v[136:139], v48, s[44:45] sc1
    global_load_dwordx4 v[140:143], v36, s[44:45] sc1
L_qs_47:
L_pv_48:
    s_mov_b64 exec, -1
    s_waitcnt vmcnt(0)
    v_xor_b32 v144, v128, v56
    v_xor_b32 v145, v129, v57
    v_xor_b32 v146, v130, v58
    v_xor_b32 v147, v131, v59
    v_xor_b32 v148, v132, v56
    v_xor_b32 v149, v133, v57
    v_xor_b32 v150, v134, v58
    v_xor_b32 v151, v135, v59
    v_xor_b32 v152, v136, v56
    v_xor_b32 v153, v137, v57
    v_xor_b32 v154, v138, v58
    v_xor_b32 v155, v139, v59
    v_xor_b32 v156, v140, v56
    v_xor_b32 v157, v141, v57
    v_xor_b32 v158, v142, v58
    v_xor_b32 v159, v143, v59
    v_or3_b32 v8, v144, v145, v146
    v_or3_b32 v9, v152, v153, v154
    v_or3_b32 v8, v8, v147, v148
    v_or3_b32 v9, v9, v155, v156
    v_or3_b32 v8, v8, v149, v150
    v_or3_b32 v9, v9, v157, v158
    v_or3_b32 v8, v8, v151, v159
    v_bitop3_b32 v8, v8, v9, s60 bitop3:0xa8
    v_cmp_ne_u32 vcc, 0, v8
    s_cmp_eq_u64 vcc, 0
    s_cbranch_scc1 L_ok_49
    s_mov_b64 exec, vcc
    s_sleep 2
    global_load_dwordx4 v[128:131], v48, s[42:43] sc1
    global_load_dwordx4 v[132:135], v36, s[42:43] sc1
    s_cmp_eq_u32 s92, 0
    s_cbranch_scc1 L_qs_51
    global_load_dwordx4 v[136:139], v48, s[44:45] sc1
    global_load_dwordx4 v[140:143], v36, s[44:45] sc1
L_qs_51:
    s_sub_u32 s31, s31, 64
    s_cbranch_scc0 L_pv_48
    s_mov_b32 s31, 0
    s_cmp_eq_u32 s94, 0
    s_cselect_b32 s94, 22, s94
    s_mov_b64 exec, -1
    s_waitcnt vmcnt(0)
L_ok_49:
    v_add_f32 v128, v144, v148
    v_add_f32 v129, v145, v149
    v_add_f32 v130, v146, v150
    v_add_f32 v131, v147, v151
    v_add_f32 v132, v152, v156
    v_add_f32 v133, v153, v157
    v_add_f32 v134, v154, v158
    v_add_f32 v135, v155, v159
    v_cvt_pk_bf16_f32 v144, v128, v129
    v_cvt_pk_bf16_f32 v145, v130, v131
    v_cvt_pk_bf16_f32 v146, v132, v133
    v_cvt_pk_bf16_f32 v147, v134, v135
    ds_write_b64 v37, v[144:145]
    ds_write_b64 v37, v[146:147] offset:2048
    v_mov_b32 v8, 1
    ds_write_b32 v5, v8
L_pm_52:
    s_cmp_gt_u32 s35, 0
    s_cbranch_scc1 L_ok_53
    ds_read_b128 v[8:11], v12
    s_waitcnt lgkmcnt(0)
    v_min3_u32 v8, v8, v9, v10
    v_min_u32 v8, v8, v11
    s_nop 0
    v_readfirstlane_b32 s35, v8
    s_sub_u32 s31, s31, 1
    s_cbranch_scc0 L_pm_52
    s_mov_b32 s31, 0
    s_cmp_eq_u32 s94, 0
    s_cselect_b32 s94, 23, s94
L_ok_53:
    s_mov_b32 exec_lo, 0x00ff00ff
    s_mov_b32 exec_hi, 0xff00ff00
    ds_read_b128 v[64:67], v35 offset:0
    ds_read_b128 v[68:71], v35 offset:32
    ds_read_b128 v[72:75], v35 offset:64
    ds_read_b128 v[76:79], v35 offset:96
    ds_read_b128 v[80:83], v35 offset:128
    ds_read_b128 v[84:87], v35 offset:160
    ds_read_b128 v[88:91], v35 offset:192
    ds_read_b128 v[92:95], v35 offset:224
    ds_read_b128 v[96:99], v38 offset:0
    ds_read_b128 v[100:103], v38 offset:32
    ds_read_b128 v[104:107], v38 offset:64
    ds_read_b128 v[108:111], v38 offset:96
    ds_read_b128 v[112:115], v38 offset:128
    ds_read_b128 v[116:119], v38 offset:160
    ds_read_b128 v[120:123], v38 offset:192
    ds_read_b128 v[124:127], v38 offset:224
    s_mov_b64 exec, -1
    s_add_u32 s36, s32, 8
L_pw_54:
    s_cmp_gt_u32 s33, s36
    s_cbranch_scc1 L_ok_55
    ds_read_b32 v8, v6
    s_waitcnt lgkmcnt(0)
    v_readfirstlane_b32 s33, v8
    s_sub_u32 s31, s31, 1
    s_cbranch_scc0 L_pw_54
    s_mov_b32 s31, 0
    s_cmp_eq_u32 s94, 0
    s_cselect_b32 s94, 24, s94
L_ok_55:
    v_xor_b32 v20, 0x10000, v20
    v_xor_b32 v21, 0x10000, v21
    v_xor_b32 v22, 0x10000, v22
    v_xor_b32 v23, 0x10000, v23
    v_xor_b32 v24, 0x10000, v24
    v_xor_b32 v25, 0x10000, v25
    v_xor_b32 v26, 0x10000, v26
    v_xor_b32 v27, 0x10000, v27
    ds_read_b128 v[128:131], v20 offset:0
    ds_read_b128 v[132:135], v21 offset:0
    ds_read_b128 v[136:139], v22 offset:0
    ds_read_b128 v[140:143], v23 offset:0
    ds_read_b128 v[144:147], v24 offset:0
    ds_read_b128 v[148:151], v25 offset:0
    ds_read_b128 v[152:155], v26 offset:0
    ds_read_b128 v[156:159], v27 offset:0
    s_add_u32 s36, s36, 4
    v_mov_b32 v8, s36
    s_waitcnt lgkmcnt(7)
    v_mfma_f32_16x16x32_bf16 v[160:163], v[128:131], v[64:67], 0
    s_waitcnt lgkmcnt(6)
    v_mfma_f32_16x16x32_bf16 v[160:163], v[132:135], v[68:71], v[160:163]
    s_waitcnt lgkmcnt(5)
    v_mfma_f32_16x16x32_bf16 v[160:163], v[136:139], v[72:75], v[160:163]
    s_waitcnt lgkmcnt(4)
    v_mfma_f32_16x16x32_bf16 v[160:163], v[140:143], v[76:79], v[160:163]
    s_waitcnt lgkmcnt(3)
    v_mfma_f32_16x16x32_bf16 v[160:163], v[144:147], v[80:83], v[160:163]
    s_waitcnt lgkmcnt(2)
    v_mfma_f32_16x16x32_bf16 v[160:163], v[148:151], v[84:87], v[160:163]
    s_waitcnt lgkmcnt(1)
    v_mfma_f32_16x16x32_bf16 v[160:163], v[152:155], v[88:91], v[160:163]
    s_waitcnt lgkmcnt(0)
    ds_write_b32 v4, v8
    v_mfma_f32_16x16x32_bf16 v[160:163], v[156:159], v[92:95], v[160:163]
    s_add_u32 s36, s32, 12
L_pw_56:
    s_cmp_gt_u32 s33, s36
    s_cbranch_scc1 L_ok_57
    ds_read_b32 v8, v6
    s_waitcnt lgkmcnt(0)
    v_readfirstlane_b32 s33, v8
    s_sub_u32 s31, s31, 1
    s_cbranch_scc0 L_pw_56
    s_mov_b32 s31, 0
    s_cmp_eq_u32 s94, 0
    s_cselect_b32 s94, 25, s94
L_ok_57:
    ds_read_b128 v[128:131], v20 offset:32768
    ds_read_b128 v[132:135], v21 offset:32768
    ds_read_b128 v[136:139], v22 offset:32768
    ds_read_b128 v[140:143], v23 offset:32768
    ds_read_b128 v[144:147], v24 offset:32768
    ds_read_b128 v[148:151], v25 offset:32768
    ds_read_b128 v[152:155], v26 offset:32768
    ds_read_b128 v[156:159], v27 offset:32768
    s_add_u32 s36, s36, 4
    v_mov_b32 v8, s36
    s_waitcnt lgkmcnt(7)
    v_mfma_f32_16x16x32_bf16 v[164:167], v[128:131], v[64:67], 0
    s_waitcnt lgkmcnt(6)
    v_mfma_f32_16x16x32_bf16 v[164:167], v[132:135], v[68:71], v[164:167]
    s_waitcnt lgkmcnt(5)
    v_mfma_f32_16x16x32_bf16 v[164:167], v[136:139], v[72:75], v[164:167]
    s_waitcnt lgkmcnt(4)
    v_mfma_f32_16x16x32_bf16 v[164:167], v[140:143], v[76:79], v[164:167]
    s_waitcnt lgkmcnt(3)
    v_mfma_f32_16x16x32_bf16 v[164:167], v[144:147], v[80:83], v[164:167]
    s_waitcnt lgkmcnt(2)
    v_mfma_f32_16x16x32_bf16 v[164:167], v[148:151], v[84:87], v[164:167]
    s_waitcnt lgkmcnt(1)
    v_mfma_f32_16x16x32_bf16 v[164:167], v[152:155], v[88:91], v[164:167]
    s_waitcnt lgkmcnt(0)
    ds_write_b32 v4, v8
    v_mfma_f32_16x16x32_bf16 v[164:167], v[156:159], v[92:95], v[164:167]
    s_add_u32 s36, s32, 16
L_pw_58:
    s_cmp_gt_u32 s33, s36
    s_cbranch_scc1 L_ok_59
    ds_read_b32 v8, v6
    s_waitcnt lgkmcnt(0)
    v_readfirstlane_b32 s33, v8
    s_sub_u32 s31, s31, 1
    s_cbranch_scc0 L_pw_58
    s_mov_b32 s31, 0
    s_cmp_eq_u32 s94, 0
    s_cselect_b32 s94, 26, s94
L_ok_59:
    v_xor_b32 v20, 0x10000, v20
    v_xor_b32 v21, 0x10000, v21
    v_xor_b32 v22, 0x10000, v22
    v_xor_b32 v23, 0x10000, v23
    v_xor_b32 v24, 0x10000, v24
    v_xor_b32 v25, 0x10000, v25
    v_xor_b32 v26, 0x10000, v26
    v_xor_b32 v27, 0x10000, v27
    ds_read_b128 v[128:131], v20 offset:0
    ds_read_b128 v[132:135], v21 offset:0
    ds_read_b128 v[136:139], v22 offset:0
    ds_read_b128 v[140:143], v23 offset:0
    ds_read_b128 v[144:147], v24 offset:0
    ds_read_b128 v[148:151], v25 offset:0
    ds_read_b128 v[152:155], v26 offset:0
    ds_read_b128 v[156:159], v27 offset:0
    s_add_u32 s36, s36, 4
    v_mov_b32 v8, s36
    s_waitcnt lgkmcnt(7)
    v_mfma_f32_16x16x32_bf16 v[168:171], v[128:131], v[64:67], 0
    s_waitcnt lgkmcnt(6)
    v_mfma_f32_16x16x32_bf16 v[168:171], v[132:135], v[68:71], v[168:171]
    s_waitcnt lgkmcnt(5)
    v_mfma_f32_16x16x32_bf16 v[168:171], v[136:139], v[72:75], v[168:171]
    s_waitcnt lgkmcnt(4)
    v_mfma_f32_16x16x32_bf16 v[168:171], v[140:143], v[76:79], v[168:171]
    s_waitcnt lgkmcnt(3)
    v_mfma_f32_16x16x32_bf16 v[168:171], v[144:147], v[80:83], v[168:171]
    s_waitcnt lgkmcnt(2)
    v_mfma_f32_16x16x32_bf16 v[168:171], v[148:151], v[84:87], v[168:171]
    s_waitcnt lgkmcnt(1)
    v_mfma_f32_16x16x32_bf16 v[168:171], v[152:155], v[88:91], v[168:171]
    s_waitcnt lgkmcnt(0)
    ds_write_b32 v4, v8
    v_mfma_f32_16x16x32_bf16 v[168:171], v[156:159], v[92:95], v[168:171]
    s_add_u32 s36, s32, 20
L_pw_60:
    s_cmp_gt_u32 s33, s36
    s_cbranch_scc1 L_ok_61
    ds_read_b32 v8, v6
    s_waitcnt lgkmcnt(0)
    v_readfirstlane_b32 s33, v8
    s_sub_u32 s31, s31, 1
    s_cbranch_scc0 L_pw_60
    s_mov_b32 s31, 0
    s_cmp_eq_u32 s94, 0
    s_cselect_b32 s94, 27, s94
L_ok_61:
    ds_read_b128 v[128:131], v20 offset:32768
    ds_read_b128 v[132:135], v21 offset:32768
    ds_read_b128 v[136:139], v22 offset:32768
    ds_read_b128 v[140:143], v23 offset:32768
    ds_read_b128 v[144:147], v24 offset:32768
    ds_read_b128 v[148:151], v25 offset:32768
    ds_read_b128 v[152:155], v26 offset:32768
    ds_read_b128 v[156:159], v27 offset:32768
    s_add_u32 s36, s36, 4
    v_mov_b32 v8, s36
    s_waitcnt lgkmcnt(7)
    v_mfma_f32_16x16x32_bf16 v[172:175], v[128:131], v[64:67], 0
    s_waitcnt lgkmcnt(6)
    v_mfma_f32_16x16x32_bf16 v[172:175], v[132:135], v[68:71], v[172:175]
    s_waitcnt lgkmcnt(5)
    v_mfma_f32_16x16x32_bf16 v[172:175], v[136:139], v[72:75], v[172:175]
    s_waitcnt lgkmcnt(4)
    v_mfma_f32_16x16x32_bf16 v[172:175], v[140:143], v[76:79], v[172:175]
    s_waitcnt lgkmcnt(3)
    v_mfma_f32_16x16x32_bf16 v[172:175], v[144:147], v[80:83], v[172:175]
    s_waitcnt lgkmcnt(2)
    v_mfma_f32_16x16x32_bf16 v[172:175], v[148:151], v[84:87], v[172:175]
    s_waitcnt lgkmcnt(1)
    v_mfma_f32_16x16x32_bf16 v[172:175], v[152:155], v[88:91], v[172:175]
    s_waitcnt lgkmcnt(0)
    ds_write_b32 v4, v8
    v_mfma_f32_16x16x32_bf16 v[172:175], v[156:159], v[92:95], v[172:175]
    s_add_u32 s36, s32, 24
L_pw_62:
    s_cmp_gt_u32 s33, s36
    s_cbranch_scc1 L_ok_63
    ds_read_b32 v8, v6
    s_waitcnt lgkmcnt(0)
    v_readfirstlane_b32 s33, v8
    s_sub_u32 s31, s31, 1
    s_cbranch_scc0 L_pw_62
    s_mov_b32 s31, 0
    s_cmp_eq_u32 s94, 0
    s_cselect_b32 s94, 28, s94
L_ok_63:
    v_xor_b32 v20, 0x10000, v20
    v_xor_b32 v21, 0x10000, v21
    v_xor_b32 v22, 0x10000, v22
    v_xor_b32 v23, 0x10000, v23
    v_xor_b32 v24, 0x10000, v24
    v_xor_b32 v25, 0x10000, v25
    v_xor_b32 v26, 0x10000, v26
    v_xor_b32 v27, 0x10000, v27
    ds_read_b128 v[128:131], v20 offset:0
    ds_read_b128 v[132:135], v21 offset:0
    ds_read_b128 v[136:139], v22 offset:0
    ds_read_b128 v[140:143], v23 offset:0
    ds_read_b128 v[144:147], v24 offset:0
    ds_read_b128 v[148:151], v25 offset:0
    ds_read_b128 v[152:155], v26 offset:0
    ds_read_b128 v[156:159], v27 offset:0
    s_add_u32 s36, s36, 4
    v_mov_b32 v8, s36
    s_waitcnt lgkmcnt(7)
    v_mfma_f32_16x16x32_bf16 v[176:179], v[128:131], v[64:67], 0
    s_waitcnt lgkmcnt(6)
    v_mfma_f32_16x16x32_bf16 v[176:179], v[132:135], v[68:71], v[176:179]
    s_waitcnt lgkmcnt(5)
    v_mfma_f32_16x16x32_bf16 v[176:179], v[136:139], v[72:75], v[176:179]
    s_waitcnt lgkmcnt(4)
    v_mfma_f32_16x16x32_bf16 v[176:179], v[140:143], v[76:79], v[176:179]
    s_waitcnt lgkmcnt(3)
    v_mfma_f32_16x16x32_bf16 v[176:179], v[144:147], v[80:83], v[176:179]
    s_waitcnt lgkmcnt(2)
    v_mfma_f32_16x16x32_bf16 v[176:179], v[148:151], v[84:87], v[176:179]
    s_waitcnt lgkmcnt(1)
    v_mfma_f32_16x16x32_bf16 v[176:179], v[152:155], v[88:91], v[176:179]
    s_waitcnt lgkmcnt(0)
    ds_write_b32 v4, v8
    v_mfma_f32_16x16x32_bf16 v[176:179], v[156:159], v[92:95], v[176:179]
    s_add_u32 s36, s32, 28
L_pw_64:
    s_cmp_gt_u32 s33, s36
    s_cbranch_scc1 L_ok_65
    ds_read_b32 v8, v6
    s_waitcnt lgkmcnt(0)
    v_readfirstlane_b32 s33, v8
    s_sub_u32 s31, s31, 1
    s_cbranch_scc0 L_pw_64
    s_mov_b32 s31, 0
    s_cmp_eq_u32 s94, 0
    s_cselect_b32 s94, 29, s94
L_ok_65:
    ds_read_b128 v[128:131], v20 offset:32768
    ds_read_b128 v[132:135], v21 offset:32768
    ds_read_b128 v[136:139], v22 offset:32768
    ds_read_b128 v[140:143], v23 offset:32768
    ds_read_b128 v[144:147], v24 offset:32768
    ds_read_b128 v[148:151], v25 offset:32768
    ds_read_b128 v[152:155], v26 offset:32768
    ds_read_b128 v[156:159], v27 offset:32768
    s_add_u32 s36, s36, 4
    v_mov_b32 v8, s36
    s_waitcnt lgkmcnt(7)
    v_mfma_f32_16x16x32_bf16 v[180:183], v[128:131], v[64:67], 0
    s_waitcnt lgkmcnt(6)
    v_mfma_f32_16x16x32_bf16 v[180:183], v[132:135], v[68:71], v[180:183]
    s_waitcnt lgkmcnt(5)
    v_mfma_f32_16x16x32_bf16 v[180:183], v[136:139], v[72:75], v[180:183]
    s_waitcnt lgkmcnt(4)
    v_mfma_f32_16x16x32_bf16 v[180:183], v[140:143], v[76:79], v[180:183]
    s_waitcnt lgkmcnt(3)
    v_mfma_f32_16x16x32_bf16 v[180:183], v[144:147], v[80:83], v[180:183]
    s_waitcnt lgkmcnt(2)
    v_mfma_f32_16x16x32_bf16 v[180:183], v[148:151], v[84:87], v[180:183]
    s_waitcnt lgkmcnt(1)
    v_mfma_f32_16x16x32_bf16 v[180:183], v[152:155], v[88:91], v[180:183]
    s_waitcnt lgkmcnt(0)
    ds_write_b32 v4, v8
    v_mfma_f32_16x16x32_bf16 v[180:183], v[156:159], v[92:95], v[180:183]
    s_add_u32 s36, s32, 32
L_pw_66:
    s_cmp_gt_u32 s33, s36
    s_cbranch_scc1 L_ok_67
    ds_read_b32 v8, v6
    s_waitcnt lgkmcnt(0)
    v_readfirstlane_b32 s33, v8
    s_sub_u32 s31, s31, 1
    s_cbranch_scc0 L_pw_66
    s_mov_b32 s31, 0
    s_cmp_eq_u32 s94, 0
    s_cselect_b32 s94, 30, s94
L_ok_67:
    v_xor_b32 v20, 0x10000, v20
    v_xor_b32 v21, 0x10000, v21
    v_xor_b32 v22, 0x10000, v22
    v_xor_b32 v23, 0x10000, v23
    v_xor_b32 v24, 0x10000, v24
    v_xor_b32 v25, 0x10000, v25
    v_xor_b32 v26, 0x10000, v26
    v_xor_b32 v27, 0x10000, v27
    ds_read_b128 v[128:131], v20 offset:0
    ds_read_b128 v[132:135], v21 offset:0
    ds_read_b128 v[136:139], v22 offset:0
    ds_read_b128 v[140:143], v23 offset:0
    ds_read_b128 v[144:147], v24 offset:0
    ds_read_b128 v[148:151], v25 offset:0
    ds_read_b128 v[152:155], v26 offset:0
    ds_read_b128 v[156:159], v27 offset:0
    s_add_u32 s36, s36, 4
    v_mov_b32 v8, s36
    s_waitcnt lgkmcnt(7)
    v_mfma_f32_16x16x32_bf16 v[184:187], v[128:131], v[64:67], 0
    s_waitcnt lgkmcnt(6)
    v_mfma_f32_16x16x32_bf16 v[184:187], v[132:135], v[68:71], v[184:187]
    s_waitcnt lgkmcnt(5)
    v_mfma_f32_16x16x32_bf16 v[184:187], v[136:139], v[72:75], v[184:187]
    s_waitcnt lgkmcnt(4)
    v_mfma_f32_16x16x32_bf16 v[184:187], v[140:143], v[76:79], v[184:187]
    s_waitcnt lgkmcnt(3)
    v_mfma_f32_16x16x32_bf16 v[184:187], v[144:147], v[80:83], v[184:187]
    s_waitcnt lgkmcnt(2)
    v_mfma_f32_16x16x32_bf16 v[184:187], v[148:151], v[84:87], v[184:187]
    s_waitcnt lgkmcnt(1)
    v_mfma_f32_16x16x32_bf16 v[184:187], v[152:155], v[88:91], v[184:187]
    s_waitcnt lgkmcnt(0)
    ds_write_b32 v4, v8
    v_mfma_f32_16x16x32_bf16 v[184:187], v[156:159], v[92:95], v[184:187]
    s_add_u32 s36, s32, 36
L_pw_68:
    s_cmp_gt_u32 s33, s36
    s_cbranch_scc1 L_ok_69
    ds_read_b32 v8, v6
    s_waitcnt lgkmcnt(0)
    v_readfirstlane_b32 s33, v8
    s_sub_u32 s31, s31, 1
    s_cbranch_scc0 L_pw_68
    s_mov_b32 s31, 0
    s_cmp_eq_u32 s94, 0
    s_cselect_b32 s94, 31, s94
L_ok_69:
    ds_read_b128 v[128:131], v20 offset:32768
    ds_read_b128 v[132:135], v21 offset:32768
    ds_read_b128 v[136:139], v22 offset:32768
    ds_read_b128 v[140:143], v23 offset:32768
    ds_read_b128 v[144:147], v24 offset:32768
    ds_read_b128 v[148:151], v25 offset:32768
    ds_read_b128 v[152:155], v26 offset:32768
    ds_read_b128 v[156:159], v27 offset:32768
    s_add_u32 s36, s36, 4
    v_mov_b32 v8, s36
    s_waitcnt lgkmcnt(7)
    v_mfma_f32_16x16x32_bf16 v[188:191], v[128:131], v[64:67], 0
    s_waitcnt lgkmcnt(6)
    v_mfma_f32_16x16x32_bf16 v[188:191], v[132:135], v[68:71], v[188:191]
    s_waitcnt lgkmcnt(5)
    v_mfma_f32_16x16x32_bf16 v[188:191], v[136:139], v[72:75], v[188:191]
    s_waitcnt lgkmcnt(4)
    v_mfma_f32_16x16x32_bf16 v[188:191], v[140:143], v[76:79], v[188:191]
    s_waitcnt lgkmcnt(3)
    v_mfma_f32_16x16x32_bf16 v[188:191], v[144:147], v[80:83], v[188:191]
    s_waitcnt lgkmcnt(2)
    v_mfma_f32_16x16x32_bf16 v[188:191], v[148:151], v[84:87], v[188:191]
    s_waitcnt lgkmcnt(1)
    v_mfma_f32_16x16x32_bf16 v[188:191], v[152:155], v[88:91], v[188:191]
    s_waitcnt lgkmcnt(0)
    ds_write_b32 v4, v8
    v_mfma_f32_16x16x32_bf16 v[188:191], v[156:159], v[92:95], v[188:191]
    s_add_u32 s36, s32, 40
L_pw_70:
    s_cmp_gt_u32 s33, s36
    s_cbranch_scc1 L_ok_71
    ds_read_b32 v8, v6
    s_waitcnt lgkmcnt(0)
    v_readfirstlane_b32 s33, v8
    s_sub_u32 s31, s31, 1
    s_cbranch_scc0 L_pw_70
    s_mov_b32 s31, 0
    s_cmp_eq_u32 s94, 0
    s_cselect_b32 s94, 32, s94
L_ok_71:
    v_xor_b32 v20, 0x10000, v20
    v_xor_b32 v21, 0x10000, v21
    v_xor_b32 v22, 0x10000, v22
    v_xor_b32 v23, 0x10000, v23
    v_xor_b32 v24, 0x10000, v24
    v_xor_b32 v25, 0x10000, v25
    v_xor_b32 v26, 0x10000, v26
    v_xor_b32 v27, 0x10000, v27
    ds_read_b128 v[128:131], v20 offset:0
    ds_read_b128 v[132:135], v21 offset:0
    ds_read_b128 v[136:139], v22 offset:0
    ds_read_b128 v[140:143], v23 offset:0
    ds_read_b128 v[144:147], v24 offset:0
    ds_read_b128 v[148:151], v25 offset:0
    ds_read_b128 v[152:155], v26 offset:0
    ds_read_b128 v[156:159], v27 offset:0
    s_mov_b32 s36, 44
    v_mov_b32 v8, s36
    s_waitcnt lgkmcnt(7)
    v_mfma_f32_16x16x32_bf16 v[192:195], v[128:131], v[96:99], 0
    s_waitcnt lgkmcnt(6)
    v_mfma_f32_16x16x32_bf16 v[192:195], v[132:135], v[100:103], v[192:195]
    s_waitcnt lgkmcnt(5)
    v_mfma_f32_16x16x32_bf16 v[192:195], v[136:139], v[104:107], v[192:195]
    s_waitcnt lgkmcnt(4)
    v_mfma_f32_16x16x32_bf16 v[192:195], v[140:143], v[108:111], v[192:195]
    s_waitcnt lgkmcnt(3)
    v_mfma_f32_16x16x32_bf16 v[192:195], v[144:147], v[112:115], v[192:195]
    s_waitcnt lgkmcnt(2)
    v_mfma_f32_16x16x32_bf16 v[192:195], v[148:151], v[116:119], v[192:195]
    s_waitcnt lgkmcnt(1)
    v_mfma_f32_16x16x32_bf16 v[192:195], v[152:155], v[120:123], v[192:195]
    s_waitcnt lgkmcnt(0)
    ds_write_b32 v4, v8
    v_mfma_f32_16x16x32_bf16 v[192:195], v[156:159], v[124:127], v[192:195]
    s_mov_b32 s38, 0x3e0293ee
    v_max_f32 v35, v160, v161
    v_max3_f32 v35, v35, v162, v163
    v_max3_f32 v35, v35, v164, v165
    v_max3_f32 v35, v35, v166, v167
    v_max3_f32 v35, v35, v168, v169
    v_max3_f32 v35, v35, v170, v171
    v_max3_f32 v35, v35, v172, v173
    v_max3_f32 v35, v35, v174, v175
    v_max3_f32 v35, v35, v176, v177
    v_max3_f32 v35, v35, v178, v179
    v_max3_f32 v35, v35, v180, v181
    v_max3_f32 v35, v35, v182, v183
    v_max3_f32 v35, v35, v184, v185
    v_max3_f32 v35, v35, v186, v187
    v_max3_f32 v35, v35, v188, v189
    v_max3_f32 v35, v35, v190, v191
    v_max3_f32 v34, v192, v193, v194
    v_max_f32 v34, v34, v195
    s_nop 1
    v_max_f32_dpp v34, v34, v34 row_ror:8 row_mask:0xf bank_mask:0xf
    v_mov_b32 v36, v34
    s_nop 1
    v_permlane16_swap_b32 v34, v36
    v_max_f32 v34, v34, v36
    v_mov_b32 v36, v34
    s_nop 1
    v_permlane32_swap_b32 v34, v36
    v_max_f32 v34, v34, v36
    s_nop 1
    v_max_f32_dpp v35, v35, v35 row_ror:8 row_mask:0xf bank_mask:0xf
    v_mov_b32 v36, v35
    s_nop 1
    v_permlane16_swap_b32 v35, v36
    v_max_f32 v35, v35, v36
    v_mov_b32 v36, v35
    s_nop 1
    v_permlane32_swap_b32 v35, v36
    v_max_f32 v35, v35, v36
    v_mul_f32 v34, s38, v34
    v_mul_f32 v35, s38, v35
    v_and_b32 v17, 7, v0
    v_lshlrev_b32 v17, 2, v17
    v_add_u32 v18, 152576, v17
    s_lshl_b32 s39, s32, 6
    v_add_u32 v17, s39, v18
    ds_write_b32 v17, v35
    ds_write_b32 v17, v34 offset:32
    v_mov_b32 v8, 2
    ds_write_b32 v5, v8
L_pm_72:
    s_cmp_gt_u32 s35, 1
    s_cbranch_scc1 L_ok_73
    ds_read_b128 v[8:11], v12
    s_waitcnt lgkmcnt(0)
    v_min3_u32 v8, v8, v9, v10
    v_min_u32 v8, v8, v11
    s_nop 0
    v_readfirstlane_b32 s35, v8
    s_sub_u32 s31, s31, 1
    s_cbranch_scc0 L_pm_72
    s_mov_b32 s31, 0
    s_cmp_eq_u32 s94, 0
    s_cselect_b32 s94, 33, s94
L_ok_73:
    ds_read_b32 v128, v18 offset:0
    ds_read_b32 v132, v18 offset:32
    ds_read_b32 v129, v18 offset:64
    ds_read_b32 v133, v18 offset:96
    ds_read_b32 v130, v18 offset:128
    ds_read_b32 v134, v18 offset:160
    ds_read_b32 v131, v18 offset:192
    ds_read_b32 v135, v18 offset:224
    s_waitcnt lgkmcnt(0)
    v_max3_f32 v35, v128, v129, v130
    v_max_f32 v35, v35, v131
    v_max3_f32 v34, v132, v133, v134
    v_max_f32 v34, v34, v135
    s_cmp_eq_u32 s92, 1
    s_cbranch_scc1 L_twomax
    v_max_f32 v35, v35, v34
    v_mov_b32 v34, v35
L_twomax:
    v_fma_f32 v160, v160, s38, -v35
    v_fma_f32 v161, v161, s38, -v35
    v_fma_f32 v162, v162, s38, -v35
    v_fma_f32 v163, v163, s38, -v35
    v_fma_f32 v164, v164, s38, -v35
    v_fma_f32 v165, v165, s38, -v35
    v_fma_f32 v166, v166, s38, -v35
    v_fma_f32 v167, v167, s38, -v35
    v_fma_f32 v168, v168, s38, -v35
    v_fma_f32 v169, v169, s38, -v35
    v_fma_f32 v170, v170, s38, -v35
    v_fma_f32 v171, v171, s38, -v35
    v_fma_f32 v172, v172, s38, -v35
    v_fma_f32 v173, v173, s38, -v35
    v_fma_f32 v174, v174, s38, -v35
    v_fma_f32 v175, v175, s38, -v35
    v_fma_f32 v176, v176, s38, -v35
    v_fma_f32 v177, v177, s38, -v35
    v_fma_f32 v178, v178, s38, -v35
    v_fma_f32 v179, v179, s38, -v35
    v_fma_f32 v180, v180, s38, -v35
    v_fma_f32 v181, v181, s38, -v35
    v_fma_f32 v182, v182, s38, -v35
    v_fma_f32 v183, v183, s38, -v35
    v_fma_f32 v184, v184, s38, -v35
    v_fma_f32 v185, v185, s38, -v35
    v_fma_f32 v186, v186, s38, -v35
    v_fma_f32 v187, v187, s38, -v35
    v_fma_f32 v188, v188, s38, -v35
    v_fma_f32 v189, v189, s38, -v35
    v_fma_f32 v190, v190, s38, -v35
    v_fma_f32 v191, v191, s38, -v35
    v_fma_f32 v192, v192, s38, -v34
    v_fma_f32 v193, v193, s38, -v34
    v_fma_f32 v194, v194, s38, -v34
    v_fma_f32 v195, v195, s38, -v34
    v_exp_f32 v160, v160
    v_exp_f32 v161, v161
    v_exp_f32 v162, v162
    v_exp_f32 v163, v163
    v_exp_f32 v164, v164
    v_exp_f32 v165, v165
    v_exp_f32 v166, v166
    v_exp_f32 v167, v167
    v_exp_f32 v168, v168
    v_exp_f32 v169, v169
    v_exp_f32 v170, v170
    v_exp_f32 v171, v171
    v_exp_f32 v172, v172
    v_exp_f32 v173, v173
    v_exp_f32 v174, v174
    v_exp_f32 v175, v175
    v_exp_f32 v176, v176
    v_exp_f32 v177, v177
    v_exp_f32 v178, v178
    v_exp_f32 v179, v179
    v_exp_f32 v180, v180
    v_exp_f32 v181, v181
    v_exp_f32 v182, v182
    v_exp_f32 v183, v183
    v_exp_f32 v184, v184
    v_exp_f32 v185, v185
    v_exp_f32 v186, v186
    v_exp_f32 v187, v187
    v_exp_f32 v188, v188
    v_exp_f32 v189, v189
    v_exp_f32 v190, v190
    v_exp_f32 v191, v191
    v_exp_f32 v192, v192
    v_exp_f32 v193, v193
    v_exp_f32 v194, v194
    v_exp_f32 v195, v195
    s_nop 0
    v_cvt_pk_bf16_f32 v128, v160, v161
    v_cvt_pk_bf16_f32 v129, v162, v163
    ds_write_b64 v32, v[128:129] offset:0
    v_cvt_pk_bf16_f32 v130, v164, v165
    v_cvt_pk_bf16_f32 v131, v166, v167
    ds_write_b64 v32, v[130:131] offset:2048
    v_cvt_pk_bf16_f32 v132, v168, v169
    v_cvt_pk_bf16_f32 v133, v170, v171
    ds_write_b64 v32, v[132:133] offset:4096
    v_cvt_pk_bf16_f32 v134, v172, v173
    v_cvt_pk_bf16_f32 v135, v174, v175
    ds_write_b64 v32, v[134:135] offset:6144
    v_cvt_pk_bf16_f32 v136, v176, v177
    v_cvt_pk_bf16_f32 v137, v178, v179
    ds_write_b64 v32, v[136:137] offset:8192
    v_cvt_pk_bf16_f32 v138, v180, v181
    v_cvt_pk_bf16_f32 v139, v182, v183
    ds_write_b64 v32, v[138:139] offset:10240
    v_cvt_pk_bf16_f32 v140, v184, v185
    v_cvt_pk_bf16_f32 v141, v186, v187
    ds_write_b64 v32, v[140:141] offset:12288
    v_cvt_pk_bf16_f32 v142, v188, v189
    v_cvt_pk_bf16_f32 v143, v190, v191
    ds_write_b64 v32, v[142:143] offset:14336
    v_cvt_pk_bf16_f32 v144, v192, v193
    v_cvt_pk_bf16_f32 v145, v194, v195
    ds_write_b64 v32, v[144:145] offset:16384
    v_add_f32 v34, v192, v193
    v_add_f32 v36, v194, v195
    v_add_f32 v34, v34, v36
    v_add_f32 v160, v160, v176
    v_add_f32 v161, v161, v177
    v_add_f32 v162, v162, v178
    v_add_f32 v163, v163, v179
    v_add_f32 v164, v164, v180
    v_add_f32 v165, v165, v181
    v_add_f32 v166, v166, v182
    v_add_f32 v167, v167, v183
    v_add_f32 v168, v168, v184
    v_add_f32 v169, v169, v185
    v_add_f32 v170, v170, v186
    v_add_f32 v171, v171, v187
    v_add_f32 v172, v172, v188
    v_add_f32 v173, v173, v189
    v_add_f32 v174, v174, v190
    v_add_f32 v175, v175, v191
    v_add_f32 v160, v160, v168
    v_add_f32 v161, v161, v169
    v_add_f32 v162, v162, v170
    v_add_f32 v163, v163, v171
    v_add_f32 v164, v164, v172
    v_add_f32 v165, v165, v173
    v_add_f32 v166, v166, v174
    v_add_f32 v167, v167, v175
    v_add_f32 v160, v160, v164
    v_add_f32 v161, v161, v165
    v_add_f32 v162, v162, v166
    v_add_f32 v163, v163, v167
    v_add_f32 v160, v160, v162
    v_add_f32 v161, v161, v163
    v_add_f32 v160, v160, v161
    v_mov_b32 v35, v160
    s_nop 1
    v_add_f32_dpp v34, v34, v34 row_ror:8 row_mask:0xf bank_mask:0xf
    v_mov_b32 v36, v34
    s_nop 1
    v_permlane16_swap_b32 v34, v36
    v_add_f32 v34, v34, v36
    v_mov_b32 v36, v34
    s_nop 1
    v_permlane32_swap_b32 v34, v36
    v_add_f32 v34, v34, v36
    s_nop 1
    v_add_f32_dpp v35, v35, v35 row_ror:8 row_mask:0xf bank_mask:0xf
    v_mov_b32 v36, v35
    s_nop 1
    v_permlane16_swap_b32 v35, v36
    v_add_f32 v35, v35, v36
    v_mov_b32 v36, v35
    s_nop 1
    v_permlane32_swap_b32 v35, v36
    v_add_f32 v35, v35, v36
    ds_write_b32 v17, v35 offset:256
    ds_write_b32 v17, v34 offset:288
    v_mov_b32 v8, 3
    ds_write_b32 v5, v8
    v_and_b32 v37, 7, v0
    v_lshlrev_b32 v37, 15, v37
    v_bfe_u32 v18, v0, 3, 1
    v_lshl_add_u32 v37, v18, 6, v37
    v_lshl_add_u32 v37, v1, 4, v37
    s_bfe_u32 s38, s2, 0x20005
    s_lshl_b32 s38, s38, 18
    s_lshl_b32 s39, s32, 13
    s_add_u32 s38, s38, s39
    s_lshr_b32 s39, s2, 7
    s_lshl_b32 s39, s39, 12
    s_add_u32 s38, s38, s39
    s_and_b32 s39, s2, 31
    s_lshl_b32 s39, s39, 7
    s_add_u32 s38, s38, s39
    s_add_u32 s38, s38, 0x100000
    s_add_u32 s42, s28, s38
    s_addc_u32 s43, s29, 0
    s_add_u32 s44, s42, 0x100000
    s_addc_u32 s45, s43, 0
    s_mov_b32 s46, 0xff00ff00
    s_mov_b32 s47, 0xff00ff00
    s_mov_b32 s89, s2
    s_lshr_b32 s38, s89, 1
    s_lshl_b32 s38, s38, 14
    s_and_b32 s39, s32, 1
    s_lshl_b32 s39, s39, 13
    s_add_u32 s38, s38, s39
    s_lshr_b32 s39, s32, 1
    s_lshl_b32 s39, s39, 12
    s_add_u32 s38, s38, s39
    s_add_u32 s38, s38, 0x100000
    s_add_u32 s48, s28, s38
    s_addc_u32 s49, s29, 0
    s_bfe_u32 s38, s89, 0x20005
    s_lshr_b32 s39, s32, 1
    s_lshl_b32 s39, s39, 2
    s_add_u32 s38, s38, s39
    s_lshl_b32 s38, s38, 3
    s_mov_b64 s[58:59], 0xff
    s_lshl_b64 s[58:59], s[58:59], s38
    s_cmp_lt_u32 s89, 128
    s_cselect_b64 s[58:59], -1, s[58:59]
    v_and_b32 v49, 1, v0
    v_lshlrev_b32 v49, 18, v49
    v_bfe_u32 v18, v0, 2, 2
    v_lshl_add_u32 v49, v18, 13, v49
    v_bfe_u32 v18, v0, 1, 1
    v_lshl_add_u32 v49, v18, 6, v49
    v_lshl_add_u32 v49, v1, 4, v49
    s_lshr_b32 s38, s89, 7
    s_lshl_b32 s38, s38, 19
    s_and_b32 s39, s89, 1
    s_lshl_b32 s39, s39, 17
    s_add_u32 s38, s38, s39
    s_lshl_b32 s39, s32, 15
    s_add_u32 s38, s38, s39
    s_bfe_u32 s39, s89, 0x60001
    s_lshl_b32 s39, s39, 7
    s_add_u32 s38, s38, s39
    s_add_u32 s38, s38, 0x300000
    s_add_u32 s50, s28, s38
    s_addc_u32 s51, s29, 0
    s_and_b32 s38, s2, 127
    s_lshl_b32 s38, s38, 13
    s_lshl_b32 s39, s32, 11
    s_add_u32 s38, s38, s39
    s_add_u32 s38, s38, 0x300000
    s_add_u32 s54, s28, s38
    s_addc_u32 s55, s29, 0
    s_bfe_u32 s38, s2, 0x10005
    s_lshl_b32 s38, s38, 12
    s_bfe_u32 s39, s2, 0x10006
    s_lshl_b32 s39, s39, 11
    s_add_u32 s38, s38, s39
    s_and_b32 s39, s2, 31
    s_lshl_b32 s39, s39, 6
    s_add_u32 s38, s38, s39
    s_add_u32 s56, s24, s38
    s_addc_u32 s57, s25, 0
    v_lshrrev_b32 v18, 1, v1
    v_and_b32 v19, 1, v1
    v_lshl_or_b32 v18, v19, 1, v18
    v_and_b32 v19, 7, v0
    v_lshlrev_b32 v51, 4, v19
    v_lshl_add_u32 v51, v18, 2, v51
    s_lshl_b32 s38, s32, 7
    s_add_u32 s38, s38, 154112
    v_add_u32 v51, s38, v51
    v_and_b32 v50, 3, v0
    v_lshlrev_b32 v50, 4, v50
    v_lshl_add_u32 v50, v18, 1, v50
    v_bfe_u32 v19, v0, 2, 1
    v_lshl_add_u32 v50, v19, 3, v50
    s_and_b32 s38, s32, 1
    s_lshl_b32 s38, s38, 7
    s_lshr_b32 s39, s32, 1
    s_lshl_b32 s39, s39, 6
    s_add_u32 s38, s38, s39
    s_add_u32 s38, s38, 153600
    v_add_u32 v50, s38, v50
    v_and_b32 v19, 1, v0
    v_lshlrev_b32 v19, 6, v19
    v_lshl_add_u32 v19, v1, 4, v19
    v_add_u32 v19, 1536, v19
    v_lshrrev_b32 v18, 1, v2
    v_cmp_eq_u32 vcc, 0, v18
    s_nop 0
    s_nop 0
    v_cndmask_b32 v20, 0, v19, vcc
    v_cmp_eq_u32 vcc, 1, v18
    s_nop 0
    s_nop 0
    v_cndmask_b32 v21, 0, v19, vcc
    v_cmp_eq_u32 vcc, 2, v18
    s_nop 0
    s_nop 0
    v_cndmask_b32 v22, 0, v19, vcc
    v_cmp_eq_u32 vcc, 3, v18
    s_nop 0
    s_nop 0
    v_cndmask_b32 v23, 0, v19, vcc
    v_cmp_eq_u32 vcc, 4, v18
    v_add_u32 v19, 128, v19
    s_nop 0
    v_cndmask_b32 v24, 0, v19, vcc
    v_cmp_eq_u32 vcc, 5, v18
    s_nop 0
    s_nop 0
    v_cndmask_b32 v25, 0, v19, vcc
    v_cmp_eq_u32 vcc, 6, v18
    s_nop 0
    s_nop 0
    v_cndmask_b32 v26, 0, v19, vcc
    v_cmp_eq_u32 vcc, 7, v18
    s_nop 0
    s_nop 0
    v_cndmask_b32 v27, 0, v19, vcc
    v_add_u32 v20, 152064, v20
    v_add_u32 v21, 152064, v21
    v_add_u32 v22, 152064, v22
    v_add_u32 v23, 152064, v23
    v_add_u32 v24, 152064, v24
    v_add_u32 v25, 152064, v25
    v_add_u32 v26, 152064, v26
    v_add_u32 v27, 152064, v27
    v_lshrrev_b32 v52, 3, v0
    s_lshr_b32 s38, s32, 1
    s_lshl_b32 s38, s38, 5
    v_add_u32 v52, s38, v52
    v_lshlrev_b32 v52, 2, v52
    v_add_u32 v52, 153088, v52
    v_lshlrev_b32 v55, 1, v0
    v_lshlrev_b32 v54, 2, v0
    v_add_u32 v54, 154112, v54
    v_mov_b32 v160, v56
    v_mov_b32 v161, v57
    v_mov_b32 v162, v58
    v_mov_b32 v163, v59
    v_mov_b32 v164, v56
    v_mov_b32 v165, v57
    v_mov_b32 v166, v58
    v_mov_b32 v167, v59
    v_mov_b32 v168, v56
    v_mov_b32 v169, v57
    v_mov_b32 v170, v58
    v_mov_b32 v171, v59
    v_mov_b32 v172, v56
    v_mov_b32 v173, v57
    v_mov_b32 v174, v58
    v_mov_b32 v175, v59
    v_mov_b32 v204, 0
    v_mov_b32 v205, 0
    v_mov_b32 v206, 0
    v_mov_b32 v207, 0
    v_mov_b32 v208, 0
    v_mov_b32 v209, 0
    v_mov_b32 v210, 0
    v_mov_b32 v211, 0
    s_cmp_eq_u32 s92, 1
    s_cselect_b32 s61, 80, 0
L_pw_74:
    s_cmp_gt_u32 s33, 47
    s_cbranch_scc1 L_ok_75
    ds_read_b32 v8, v6
    s_waitcnt lgkmcnt(0)
    v_readfirstlane_b32 s33, v8
    s_sub_u32 s31, s31, 1
    s_cbranch_scc0 L_pw_74
    s_mov_b32 s31, 0
    s_cmp_eq_u32 s94, 0
    s_cselect_b32 s94, 34, s94
L_ok_75:
    v_add_u32 v40, 0x10000, v40
    v_add_u32 v41, 0x10000, v41
    v_add_u32 v42, 0x10000, v42
    v_add_u32 v43, 0x10000, v43
    v_add_u32 v44, 0x10000, v44
    v_add_u32 v45, 0x10000, v45
    v_add_u32 v46, 0x10000, v46
    v_add_u32 v47, 0x10000, v47
    ds_read_b64_tr_b16 v[64:65], v40 offset:32768
    ds_read_b64_tr_b16 v[66:67], v40 offset:49152
    ds_read_b64_tr_b16 v[68:69], v41 offset:32768
    ds_read_b64_tr_b16 v[70:71], v41 offset:49152
    ds_read_b64_tr_b16 v[72:73], v42 offset:32768
    ds_read_b64_tr_b16 v[74:75], v42 offset:49152
    ds_read_b64_tr_b16 v[76:77], v43 offset:32768
    ds_read_b64_tr_b16 v[78:79], v43 offset:49152
    ds_read_b64_tr_b16 v[96:97], v44 offset:32768
    ds_read_b64_tr_b16 v[98:99], v44 offset:49152
    ds_read_b64_tr_b16 v[100:101], v45 offset:32768
    ds_read_b64_tr_b16 v[102:103], v45 offset:49152
    ds_read_b64_tr_b16 v[104:105], v46 offset:32768
    ds_read_b64_tr_b16 v[106:107], v46 offset:49152
    ds_read_b64_tr_b16 v[108:109], v47 offset:32768
    ds_read_b64_tr_b16 v[110:111], v47 offset:49152
    v_subrev_u32 v40, 0x10000, v40
    v_subrev_u32 v41, 0x10000, v41
    v_subrev_u32 v42, 0x10000, v42
    v_subrev_u32 v43, 0x10000, v43
    v_subrev_u32 v44, 0x10000, v44
    v_subrev_u32 v45, 0x10000, v45
    v_subrev_u32 v46, 0x10000, v46
    v_subrev_u32 v47, 0x10000, v47
    s_waitcnt lgkmcnt(0)
    v_mov_b32 v8, 48
    ds_write_b32 v4, v8
L_pm_76:
    s_cmp_gt_u32 s35, 2
    s_cbranch_scc1 L_ok_77
    ds_read_b128 v[8:11], v12
    s_waitcnt lgkmcnt(0)
    v_min3_u32 v8, v8, v9, v10
    v_min_u32 v8, v8, v11
    s_nop 0
    v_readfirstlane_b32 s35, v8
    s_sub_u32 s31, s31, 1
    s_cbranch_scc0 L_pm_76
    s_mov_b32 s31, 0
    s_cmp_eq_u32 s94, 0
    s_cselect_b32 s94, 35, s94
L_ok_77:
    s_mov_b32 s36, 48
L_v:
    s_and_b32 s37, s36, 15
    s_lshl_b32 s37, s37, 13
    v_add_u32 v38, s37, v28
    v_add_u32 v39, s37, v29
L_pw_78:
    s_cmp_gt_u32 s33, s36
    s_cbranch_scc1 L_ok_79
    ds_read_b32 v8, v6
    s_waitcnt lgkmcnt(0)
    v_readfirstlane_b32 s33, v8
    s_sub_u32 s31, s31, 1
    s_cbranch_scc0 L_pw_78
    s_mov_b32 s31, 0
    s_cmp_eq_u32 s94, 0
    s_cselect_b32 s94, 36, s94
L_ok_79:
    ds_read_b128 v[136:139], v33
    ds_read_b64_tr_b16 v[128:129], v38
    ds_read_b64_tr_b16 v[130:131], v38 offset:4096
    ds_read_b64_tr_b16 v[132:133], v39
    ds_read_b64_tr_b16 v[134:135], v39 offset:4096
    v_add_u32 v33, 512, v33
    s_add_u32 s36, s36, 1
    v_mov_b32 v8, s36
    s_waitcnt lgkmcnt(2)
    v_mfma_f32_16x16x32_bf16 v[204:207], v[128:131], v[136:139], v[204:207]
    s_waitcnt lgkmcnt(0)
    v_mfma_f32_16x16x32_bf16 v[208:211], v[132:135], v[136:139], v[208:211]
    ds_write_b32 v4, v8
    s_cmp_eq_u32 s36, s61
    s_cbranch_scc1 L_vmid
    s_cmp_lt_u32 s36, 84
    s_cbranch_scc1 L_v
    s_nop 2
    v_cndmask_b32 v212, v204, v208, s[46:47]
    v_cndmask_b32 v213, v205, v209, s[46:47]
    v_cndmask_b32 v214, v206, v210, s[46:47]
    v_cndmask_b32 v215, v207, v211, s[46:47]
    v_bfi_b32 v212, s60, v56, v212
    v_bfi_b32 v213, s60, v57, v213
    v_bfi_b32 v214, s60, v58, v214
    v_bfi_b32 v215, s60, v59, v215
    global_store_dwordx4 v37, v[212:215], s[42:43] sc1
L_pw_80:
    s_cmp_gt_u32 s34, 1
    s_cbranch_scc1 L_ok_81
    ds_read_b32 v8, v7
    s_waitcnt lgkmcnt(0)
    v_readfirstlane_b32 s34, v8
    s_sub_u32 s31, s31, 1
    s_cbranch_scc0 L_pw_80
    s_mov_b32 s31, 0
    s_cmp_eq_u32 s94, 0
    s_cselect_b32 s94, 37, s94
L_ok_81:
    ds_read_b32 v192, v52 offset:0
    ds_read_b32 v193, v52 offset:32
    ds_read_b32 v194, v52 offset:64
    ds_read_b32 v195, v52 offset:96
L_pw_82:
    s_cmp_gt_u32 s33, 87
    s_cbranch_scc1 L_ok_83
    ds_read_b32 v8, v6
    s_waitcnt lgkmcnt(0)
    v_readfirstlane_b32 s33, v8
    s_sub_u32 s31, s31, 1
    s_cbranch_scc0 L_pw_82
    s_mov_b32 s31, 0
    s_cmp_eq_u32 s94, 0
    s_cselect_b32 s94, 38, s94
L_ok_83:
    ds_read_b64_tr_b16 v[80:81], v40 offset:32768
    ds_read_b64_tr_b16 v[82:83], v40 offset:49152
    ds_read_b64_tr_b16 v[84:85], v41 offset:32768
    ds_read_b64_tr_b16 v[86:87], v41 offset:49152
    ds_read_b64_tr_b16 v[88:89], v42 offset:32768
    ds_read_b64_tr_b16 v[90:91], v42 offset:49152
    ds_read_b64_tr_b16 v[92:93], v43 offset:32768
    ds_read_b64_tr_b16 v[94:95], v43 offset:49152
    ds_read_b64_tr_b16 v[112:113], v44 offset:32768
    ds_read_b64_tr_b16 v[114:115], v44 offset:49152
    ds_read_b64_tr_b16 v[116:117], v45 offset:32768
    ds_read_b64_tr_b16 v[118:119], v45 offset:49152
    ds_read_b64_tr_b16 v[120:121], v46 offset:32768
    ds_read_b64_tr_b16 v[122:123], v46 offset:49152
    ds_read_b64_tr_b16 v[124:125], v47 offset:32768
    ds_read_b64_tr_b16 v[126:127], v47 offset:49152
    s_mov_b64 exec, s[58:59]
    global_load_dwordx4 v[160:163], v48, s[48:49] offset:0 sc1
    global_load_dwordx4 v[164:167], v48, s[48:49] offset:1024 sc1
    global_load_dwordx4 v[168:171], v48, s[48:49] offset:2048 sc1
    global_load_dwordx4 v[172:175], v48, s[48:49] offset:3072 sc1
L_pv_84:
    s_mov_b64 exec, -1
    s_waitcnt vmcnt(0)
    v_xor_b32 v140, v160, v56
    v_xor_b32 v141, v161, v57
    v_xor_b32 v142, v162, v58
    v_xor_b32 v143, v163, v59
    v_xor_b32 v144, v164, v56
    v_xor_b32 v145, v165, v57
    v_xor_b32 v146, v166, v58
    v_xor_b32 v147, v167, v59
    v_xor_b32 v148, v168, v56
    v_xor_b32 v149, v169, v57
    v_xor_b32 v150, v170, v58
    v_xor_b32 v151, v171, v59
    v_xor_b32 v152, v172, v56
    v_xor_b32 v153, v173, v57
    v_xor_b32 v154, v174, v58
    v_xor_b32 v155, v175, v59
    v_or3_b32 v8, v140, v141, v142
    v_or3_b32 v9, v148, v149, v150
    v_or3_b32 v8, v8, v143, v144
    v_or3_b32 v9, v9, v151, v152
    v_or3_b32 v8, v8, v145, v146
    v_or3_b32 v9, v9, v153, v154
    v_or3_b32 v8, v8, v147, v155
    v_bitop3_b32 v8, v8, v9, s60 bitop3:0xa8
    v_cmp_ne_u32 vcc, 0, v8
    s_cmp_eq_u64 vcc, 0
    s_cbranch_scc1 L_ok_85
    s_mov_b64 exec, vcc
    global_load_dwordx4 v[160:163], v48, s[48:49] offset:0 sc1
    global_load_dwordx4 v[164:167], v48, s[48:49] offset:1024 sc1
    global_load_dwordx4 v[168:171], v48, s[48:49] offset:2048 sc1
    global_load_dwordx4 v[172:175], v48, s[48:49] offset:3072 sc1
    s_sub_u32 s31, s31, 64
    s_cbranch_scc0 L_pv_84
    s_mov_b32 s31, 0
    s_cmp_eq_u32 s94, 0
    s_cselect_b32 s94, 39, s94
    s_mov_b64 exec, -1
    s_waitcnt vmcnt(0)
L_ok_85:
    s_waitcnt lgkmcnt(0)
    v_mul_f32 v140, v140, v192
    v_mul_f32 v141, v141, v192
    v_mul_f32 v142, v142, v192
    v_mul_f32 v143, v143, v192
    v_fmac_f32 v140, v144, v193
    v_fmac_f32 v141, v145, v193
    v_fmac_f32 v142, v146, v193
    v_fmac_f32 v143, v147, v193
    v_fmac_f32 v140, v148, v194
    v_fmac_f32 v141, v149, v194
    v_fmac_f32 v142, v150, v194
    v_fmac_f32 v143, v151, v194
    v_fmac_f32 v140, v152, v195
    v_fmac_f32 v141, v153, v195
    v_fmac_f32 v142, v154, v195
    v_fmac_f32 v143, v155, v195
    s_nop 0
    v_permlane32_swap_b32 v140, v141
    v_permlane32_swap_b32 v142, v143
    v_add_f32 v140, v140, v141
    v_add_f32 v142, v142, v143
    s_nop 1
    v_permlane16_swap_b32 v140, v142
    v_add_f32 v140, v140, v142
    s_nop 1
    v_add_f32_dpp v140, v140, v140 row_ror:8 row_mask:0xf bank_mask:0xf
    v_cvt_pk_bf16_f32 v140, v140, v140
    ds_write_b16 v50, v140
    s_waitcnt lgkmcnt(0)
    s_barrier
    ds_read_b128 v[212:215], v20
    ds_read_b128 v[216:219], v21
    ds_read_b128 v[220:223], v22
    ds_read_b128 v[224:227], v23
    ds_read_b128 v[228:231], v24
    ds_read_b128 v[232:235], v25
    ds_read_b128 v[236:239], v26
    ds_read_b128 v[240:243], v27
    s_waitcnt lgkmcnt(7)
    v_mfma_f32_16x16x32_bf16 v[204:207], v[64:67], v[212:215], 0
    v_mfma_f32_16x16x32_bf16 v[208:211], v[96:99], v[212:215], 0
    s_waitcnt lgkmcnt(6)
    v_mfma_f32_16x16x32_bf16 v[204:207], v[68:71], v[216:219], v[204:207]
    v_mfma_f32_16x16x32_bf16 v[208:211], v[100:103], v[216:219], v[208:211]
    s_waitcnt lgkmcnt(5)
    v_mfma_f32_16x16x32_bf16 v[204:207], v[72:75], v[220:223], v[204:207]
    v_mfma_f32_16x16x32_bf16 v[208:211], v[104:107], v[220:223], v[208:211]
    s_waitcnt lgkmcnt(4)
    v_mfma_f32_16x16x32_bf16 v[204:207], v[76:79], v[224:227], v[204:207]
    v_mfma_f32_16x16x32_bf16 v[208:211], v[108:111], v[224:227], v[208:211]
    s_waitcnt lgkmcnt(3)
    v_mfma_f32_16x16x32_bf16 v[204:207], v[80:83], v[228:231], v[204:207]
    v_mfma_f32_16x16x32_bf16 v[208:211], v[112:115], v[228:231], v[208:211]
    s_waitcnt lgkmcnt(2)
    v_mfma_f32_16x16x32_bf16 v[204:207], v[84:87], v[232:235], v[204:207]
    v_mfma_f32_16x16x32_bf16 v[208:211], v[116:119], v[232:235], v[208:211]
    s_waitcnt lgkmcnt(1)
    v_mfma_f32_16x16x32_bf16 v[204:207], v[88:91], v[236:239], v[204:207]
    v_mfma_f32_16x16x32_bf16 v[208:211], v[120:123], v[236:239], v[208:211]
    s_waitcnt lgkmcnt(0)
    v_mfma_f32_16x16x32_bf16 v[204:207], v[92:95], v[240:243], v[204:207]
    v_mfma_f32_16x16x32_bf16 v[208:211], v[124:127], v[240:243], v[208:211]
    s_nop 6
    v_add_f32_dpp v200, v204, v204 row_ror:8 row_mask:0xf bank_mask:0x3
    v_add_f32_dpp v201, v205, v205 row_ror:8 row_mask:0xf bank_mask:0x3
    v_add_f32_dpp v202, v206, v206 row_ror:8 row_mask:0xf bank_mask:0x3
    v_add_f32_dpp v203, v207, v207 row_ror:8 row_mask:0xf bank_mask:0x3
    v_add_f32_dpp v200, v208, v208 row_ror:8 row_mask:0xf bank_mask:0xc
    v_add_f32_dpp v201, v209, v209 row_ror:8 row_mask:0xf bank_mask:0xc
    v_add_f32_dpp v202, v210, v210 row_ror:8 row_mask:0xf bank_mask:0xc
    v_add_f32_dpp v203, v211, v211 row_ror:8 row_mask:0xf bank_mask:0xc
    v_bfi_b32 v200, s60, v56, v200
    v_bfi_b32 v201, s60, v57, v201
    v_bfi_b32 v202, s60, v58, v202
    v_bfi_b32 v203, s60, v59, v203
    global_store_dwordx4 v49, v[200:203], s[50:51] sc1
    s_cmp_ge_u32 s2, 128
    s_cbranch_scc1 L_fin
    s_waitcnt vmcnt(0)
    global_load_dwordx4 v[160:163], v48, s[54:55] offset:0 sc1
    global_load_dwordx4 v[164:167], v48, s[54:55] offset:1024 sc1
L_pv_87:
    s_mov_b64 exec, -1
    s_waitcnt vmcnt(0)
    v_xor_b32 v140, v160, v56
    v_xor_b32 v141, v161, v57
    v_xor_b32 v142, v162, v58
    v_xor_b32 v143, v163, v59
    v_xor_b32 v144, v164, v56
    v_xor_b32 v145, v165, v57
    v_xor_b32 v146, v166, v58
    v_xor_b32 v147, v167, v59
    v_or3_b32 v8, v140, v141, v142
    v_or3_b32 v9, v144, v145, v146
    v_or3_b32 v8, v8, v143, v147
    v_bitop3_b32 v8, v8, v9, s60 bitop3:0xa8
    v_cmp_ne_u32 vcc, 0, v8
    s_cmp_eq_u64 vcc, 0
    s_cbranch_scc1 L_ok_88
    s_mov_b64 exec, vcc
    global_load_dwordx4 v[160:163], v48, s[54:55] offset:0 sc1
    global_load_dwordx4 v[164:167], v48, s[54:55] offset:1024 sc1
    s_sub_u32 s31, s31, 64
    s_cbranch_scc0 L_pv_87
    s_mov_b32 s31, 0
    s_cmp_eq_u32 s94, 0
    s_cselect_b32 s94, 40, s94
    s_mov_b64 exec, -1
    s_waitcnt vmcnt(0)
L_ok_88:
    v_add_f32 v140, v140, v144
    v_add_f32 v141, v141, v145
    v_add_f32 v142, v142, v146
    v_add_f32 v143, v143, v147
    s_nop 0
    v_permlane32_swap_b32 v140, v141
    v_permlane32_swap_b32 v142, v143
    v_add_f32 v140, v140, v141
    v_add_f32 v142, v142, v143
    s_nop 1
    v_permlane16_swap_b32 v140, v142
    v_add_f32 v140, v140, v142
    s_nop 1
    v_add_f32_dpp v140, v140, v140 row_ror:8 row_mask:0xf bank_mask:0xf
    ds_write_b32 v51, v140
    s_waitcnt lgkmcnt(0)
    s_barrier
    s_cmp_lg_u32 s32, 0
    s_cbranch_scc1 L_fin
    s_mov_b32 exec_hi, 0
    ds_read_b32 v140, v54 offset:0
    ds_read_b32 v141, v54 offset:128
    ds_read_b32 v142, v54 offset:256
    ds_read_b32 v143, v54 offset:384
    s_waitcnt lgkmcnt(0)
    v_add_f32 v140, v140, v141
    v_add_f32 v142, v142, v143
    v_add_f32 v140, v140, v142
    v_cvt_pk_bf16_f32 v140, v140, v140
    global_store_short v55, v140, s[56:57]
L_fin:
    s_cmp_eq_u32 s94, 0
    s_cbranch_scc1 L_dg_90
    s_mov_b64 exec, 1
    s_lshl_b32 s95, s2, 8
    s_or_b32 s95, s95, s94
    v_mov_b32 v1, s95
    v_mov_b32 v2, 0
    v_mov_b32 v3, 1
    global_store_dword v2, v1, s[26:27] offset:8 sc1
    global_atomic_add v2, v3, s[26:27] offset:24 sc1
    s_waitcnt vmcnt(0)
L_dg_90:
L_end:
    s_endpgm
L_vmid:
    s_nop 4
    v_cndmask_b32 v196, v204, v208, s[46:47]
    v_cndmask_b32 v197, v205, v209, s[46:47]
    v_cndmask_b32 v198, v206, v210, s[46:47]
    v_cndmask_b32 v199, v207, v211, s[46:47]
    v_bfi_b32 v196, s60, v56, v196
    v_bfi_b32 v197, s60, v57, v197
    v_bfi_b32 v198, s60, v58, v198
    v_bfi_b32 v199, s60, v59, v199
    global_store_dwordx4 v37, v[196:199], s[44:45] sc1
    v_mov_b32 v204, 0
    v_mov_b32 v205, 0
    v_mov_b32 v206, 0
    v_mov_b32 v207, 0
    v_mov_b32 v208, 0
    v_mov_b32 v209, 0
    v_mov_b32 v210, 0
    v_mov_b32 v211, 0
    s_branch L_v
.section .rodata,"a"
.p2align 6
.amdhsa_kernel concat_heads__gqa_block_cached__sliding_block_cached__decode_kernel
  .amdhsa_next_free_vgpr 248
  .amdhsa_next_free_sgpr 100
  .amdhsa_accum_offset 248
  .amdhsa_group_segment_fixed_size 0
  .amdhsa_kernarg_size 104
  .amdhsa_user_sgpr_count 2
  .amdhsa_user_sgpr_kernarg_segment_ptr 1
  .amdhsa_system_sgpr_workgroup_id_x 1
  .amdhsa_float_denorm_mode_32 3
.end_amdhsa_kernel
```
